```python
import torch

def _softmax(x, axis=-1):
    return torch.softmax(x, dim=axis)
def _gelu(x):
    return torch.nn.functional.gelu(x, approximate="tanh")
def _silu(x):
    return torch.nn.functional.silu(x)
def _sigmoid(x):
    return torch.sigmoid(x)
def _layernorm(x, axis=-1, eps=1e-5):
    m = x.mean(dim=axis, keepdim=True)
    v = x.var(dim=axis, keepdim=True, unbiased=False)
    return (x - m) / torch.sqrt(v + eps)
def _scatter_add(tgt, idx, src, axis=0):
    return tgt.clone().index_add_(axis, idx, src)
def _segment_sum(src, seg, n):
    out = torch.zeros((n,) + src.shape[1:], dtype=src.dtype)
    return out.index_add_(0, seg, src)
def _pad(x, pw):
    flat = tuple(v for pair in reversed(pw) for v in pair)
    return torch.nn.functional.pad(x, flat)

kernel_name = 'standalone__edge_featured_mpnn_egc__graph'

def setup_inputs():

    _w = (lambda a: (lambda t: t.to(torch.bfloat16) if t.is_floating_point() else t)(torch.as_tensor(a)))
    N, deg, D, De = 12500, 64, 64, max(16, 1)
    E = N * deg
    return {
        "x": _w((lambda *s: torch.randn(*s, dtype=torch.bfloat16) * 0.2)(N, D)),
        "e_attr": _w((lambda *s: torch.randn(*s, dtype=torch.bfloat16) * 0.2)(E, De)),
        "src": _w((lambda lo, hi, *s: torch.randint(lo, hi, s))(0, N, E).to(torch.int64)),
        "dst": _w((lambda lo, hi, *s: torch.randint(lo, hi, s))(0, N, E).to(torch.int64)),
        "u_w": _w((lambda *s: torch.randn(*s, dtype=torch.bfloat16) * 0.05)(D, D)),
        "v_w": _w((lambda *s: torch.randn(*s, dtype=torch.bfloat16) * 0.05)(D, D)),
        "g_w": _w((lambda *s: torch.randn(*s, dtype=torch.bfloat16) * 0.2)(2 * D + De, D)),
    }

def reference(x, e_attr, src, dst, u_w, v_w, g_w):
    N, D = x.shape
    g_in = torch.concatenate([x[dst], x[src], e_attr], axis=-1)
    eta = _sigmoid(g_in @ g_w)
    hv = x @ v_w
    msg = eta * hv[src]
    agg = _segment_sum(msg, dst, N)
    return _silu(x @ u_w + agg)
```

```asm
; @launch kernel=p1_kernel grid=(320,1,1) block=(384,1,1) lds=33792
; @launch kernel=p2_kernel grid=(256,1,1) block=(512,1,1) lds=159232
.amdgcn_target "amdgcn-amd-amdhsa--gfx950"
.text
.globl p1_kernel
.p2align 8
.type p1_kernel,@function
p1_kernel:
    s_cmp_ge_u32 s2, 320
    s_cbranch_scc1 P1_END
    s_load_dwordx16 s[16:31], s[0:1], 0
    s_load_dwordx4 s[32:35], s[0:1], 64
    v_and_b32 v1, 63, v0
    v_lshrrev_b32 v5, 6, v0
    v_lshlrev_b32 v2, 4, v0
    v_lshlrev_b32 v3, 2, v0
    v_readfirstlane_b32 s3, v5
    v_lshlrev_b32 v4, 4, v1
    s_mul_i32 s4, s2, 10000
    s_cmp_ge_u32 s3, 5
    s_cbranch_scc1 P1_AUX
    v_mov_b32 v6, 0
    v_and_b32 v7, 0x3fc, v3
    ds_write_b32 v7, v6 offset:0
    s_waitcnt lgkmcnt(0)
    s_add_u32 s44, s22, s4
    s_addc_u32 s45, s23, 0
    s_mov_b32 s46, 10000
    s_mov_b32 s47, 0x20000
    s_add_u32 s40, s20, s4
    s_addc_u32 s41, s21, 0
    s_mov_b32 s42, 10000
    s_mov_b32 s43, 0x20000
    s_mov_b32 s5, 0
    buffer_load_dwordx4 v[40:43], v2, s[44:47], s5 offen nt
    s_mov_b32 s5, 5120
    buffer_load_dwordx4 v[48:51], v2, s[44:47], s5 offen nt
    s_mov_b32 s5, 0
    buffer_load_dwordx4 v[44:47], v2, s[40:43], s5 offen nt
    s_mov_b32 s5, 5120
    buffer_load_dwordx4 v[52:55], v2, s[40:43], s5 offen nt
    s_mov_b32 s48, s34
    s_mov_b32 s49, s35
    s_mov_b32 s50, 50331648
    s_mov_b32 s51, 0x20000
    v_mov_b32 v8, -1
    v_mov_b32 v9, -1
    v_mov_b32 v10, -1
    v_mov_b32 v11, -1
    ds_write_b128 v2, v[8:11] offset:1024
    ds_write_b128 v2, v[8:11] offset:6144
    ds_write_b128 v2, v[8:11] offset:11264
    ds_write_b128 v2, v[8:11] offset:16384
    ds_write_b128 v2, v[8:11] offset:21504
    ds_write_b128 v2, v[8:11] offset:26624
    v_min_u32 v12, 2032, v2
    ds_write_b128 v12, v[8:11] offset:31744
    v_cmp_gt_u32 vcc, 305, v0
    s_mov_b64 s[8:9], vcc
    v_mov_b32 v30, 1
    v_lshrrev_b32 v7, 3, v0
    v_lshlrev_b32 v6, 2, v7
    v_and_b32 v27, 7, v0
    s_lshl_b32 s6, s2, 7
    s_add_u32 s6, s6, 0
    v_mul_u32_u24 v28, 40960, v7
    v_lshl_or_b32 v28, v27, 4, v28
    s_waitcnt lgkmcnt(0)
    s_barrier
    s_waitcnt vmcnt(3)
    v_mul_u32_u24 v56, 21400, v40
    v_lshrrev_b32 v31, 20, v56
    v_lshlrev_b32 v56, 2, v31
    ds_add_rtn_u32 v64, v56, v30 offset:0
    v_mul_u32_u24 v31, 49, v31
    v_sub_u32 v40, v40, v31
    v_mul_u32_u24 v57, 21400, v41
    v_lshrrev_b32 v31, 20, v57
    v_lshlrev_b32 v57, 2, v31
    ds_add_rtn_u32 v65, v57, v30 offset:0
    v_mul_u32_u24 v31, 49, v31
    v_sub_u32 v41, v41, v31
    v_mul_u32_u24 v58, 21400, v42
    v_lshrrev_b32 v31, 20, v58
    v_lshlrev_b32 v58, 2, v31
    ds_add_rtn_u32 v66, v58, v30 offset:0
    v_mul_u32_u24 v31, 49, v31
    v_sub_u32 v42, v42, v31
    v_mul_u32_u24 v59, 21400, v43
    v_lshrrev_b32 v31, 20, v59
    v_lshlrev_b32 v59, 2, v31
    ds_add_rtn_u32 v67, v59, v30 offset:0
    v_mul_u32_u24 v31, 49, v31
    v_sub_u32 v43, v43, v31
    s_waitcnt vmcnt(2)
    s_mov_b64 exec, s[8:9]
    v_mul_u32_u24 v60, 21400, v48
    v_lshrrev_b32 v31, 20, v60
    v_lshlrev_b32 v60, 2, v31
    ds_add_rtn_u32 v68, v60, v30 offset:0
    v_mul_u32_u24 v31, 49, v31
    v_sub_u32 v48, v48, v31
    v_mul_u32_u24 v61, 21400, v49
    v_lshrrev_b32 v31, 20, v61
    v_lshlrev_b32 v61, 2, v31
    ds_add_rtn_u32 v69, v61, v30 offset:0
    v_mul_u32_u24 v31, 49, v31
    v_sub_u32 v49, v49, v31
    v_mul_u32_u24 v62, 21400, v50
    v_lshrrev_b32 v31, 20, v62
    v_lshlrev_b32 v62, 2, v31
    ds_add_rtn_u32 v70, v62, v30 offset:0
    v_mul_u32_u24 v31, 49, v31
    v_sub_u32 v50, v50, v31
    v_mul_u32_u24 v63, 21400, v51
    v_lshrrev_b32 v31, 20, v63
    v_lshlrev_b32 v63, 2, v31
    ds_add_rtn_u32 v71, v63, v30 offset:0
    v_mul_u32_u24 v31, 49, v31
    v_sub_u32 v51, v51, v31
    s_mov_b64 exec, -1
    s_waitcnt vmcnt(0)
    v_lshl_or_b32 v40, v40, 14, v44
    v_add_u32 v31, 0, v3
    v_lshl_or_b32 v40, v31, 20, v40
    v_lshl_or_b32 v41, v41, 14, v45
    v_add_u32 v31, 1, v3
    v_lshl_or_b32 v41, v31, 20, v41
    v_lshl_or_b32 v42, v42, 14, v46
    v_add_u32 v31, 2, v3
    v_lshl_or_b32 v42, v31, 20, v42
    v_lshl_or_b32 v43, v43, 14, v47
    v_add_u32 v31, 3, v3
    v_lshl_or_b32 v43, v31, 20, v43
    v_lshl_or_b32 v48, v48, 14, v52
    v_add_u32 v31, 1280, v3
    v_lshl_or_b32 v48, v31, 20, v48
    v_lshl_or_b32 v49, v49, 14, v53
    v_add_u32 v31, 1281, v3
    v_lshl_or_b32 v49, v31, 20, v49
    v_lshl_or_b32 v50, v50, 14, v54
    v_add_u32 v31, 1282, v3
    v_lshl_or_b32 v50, v31, 20, v50
    v_lshl_or_b32 v51, v51, 14, v55
    v_add_u32 v31, 1283, v3
    v_lshl_or_b32 v51, v31, 20, v51
    s_mov_b64 s[10:11], -1
    s_waitcnt lgkmcnt(7)
    v_and_b32 v31, 7, v64
    v_lshlrev_b32 v31, 4, v31
    v_lshl_add_u32 v56, v56, 5, v31
    v_lshrrev_b32 v31, 3, v64
    v_cmp_gt_u32 vcc, 32, v64
    v_lshl_add_u32 v56, v31, 2, v56
    s_and_b64 exec, s[10:11], vcc
    ds_write_b32 v56, v40 offset:1024
    s_mov_b64 exec, -1
    s_waitcnt lgkmcnt(7)
    v_and_b32 v31, 7, v65
    v_lshlrev_b32 v31, 4, v31
    v_lshl_add_u32 v57, v57, 5, v31
    v_lshrrev_b32 v31, 3, v65
    v_cmp_gt_u32 vcc, 32, v65
    v_lshl_add_u32 v57, v31, 2, v57
    s_and_b64 exec, s[10:11], vcc
    ds_write_b32 v57, v41 offset:1024
    s_mov_b64 exec, -1
    s_waitcnt lgkmcnt(7)
    v_and_b32 v31, 7, v66
    v_lshlrev_b32 v31, 4, v31
    v_lshl_add_u32 v58, v58, 5, v31
    v_lshrrev_b32 v31, 3, v66
    v_cmp_gt_u32 vcc, 32, v66
    v_lshl_add_u32 v58, v31, 2, v58
    s_and_b64 exec, s[10:11], vcc
    ds_write_b32 v58, v42 offset:1024
    s_mov_b64 exec, -1
    s_waitcnt lgkmcnt(7)
    v_and_b32 v31, 7, v67
    v_lshlrev_b32 v31, 4, v31
    v_lshl_add_u32 v59, v59, 5, v31
    v_lshrrev_b32 v31, 3, v67
    v_cmp_gt_u32 vcc, 32, v67
    v_lshl_add_u32 v59, v31, 2, v59
    s_and_b64 exec, s[10:11], vcc
    ds_write_b32 v59, v43 offset:1024
    s_mov_b64 exec, -1
    s_mov_b64 s[10:11], s[8:9]
    s_waitcnt lgkmcnt(7)
    v_and_b32 v31, 7, v68
    v_lshlrev_b32 v31, 4, v31
    v_lshl_add_u32 v60, v60, 5, v31
    v_lshrrev_b32 v31, 3, v68
    v_cmp_gt_u32 vcc, 32, v68
    v_lshl_add_u32 v60, v31, 2, v60
    s_and_b64 exec, s[10:11], vcc
    ds_write_b32 v60, v48 offset:1024
    s_mov_b64 exec, -1
    s_waitcnt lgkmcnt(7)
    v_and_b32 v31, 7, v69
    v_lshlrev_b32 v31, 4, v31
    v_lshl_add_u32 v61, v61, 5, v31
    v_lshrrev_b32 v31, 3, v69
    v_cmp_gt_u32 vcc, 32, v69
    v_lshl_add_u32 v61, v31, 2, v61
    s_and_b64 exec, s[10:11], vcc
    ds_write_b32 v61, v49 offset:1024
    s_mov_b64 exec, -1
    s_waitcnt lgkmcnt(7)
    v_and_b32 v31, 7, v70
    v_lshlrev_b32 v31, 4, v31
    v_lshl_add_u32 v62, v62, 5, v31
    v_lshrrev_b32 v31, 3, v70
    v_cmp_gt_u32 vcc, 32, v70
    v_lshl_add_u32 v62, v31, 2, v62
    s_and_b64 exec, s[10:11], vcc
    ds_write_b32 v62, v50 offset:1024
    s_mov_b64 exec, -1
    s_waitcnt lgkmcnt(7)
    v_and_b32 v31, 7, v71
    v_lshlrev_b32 v31, 4, v31
    v_lshl_add_u32 v63, v63, 5, v31
    v_lshrrev_b32 v31, 3, v71
    v_cmp_gt_u32 vcc, 32, v71
    v_lshl_add_u32 v63, v31, 2, v63
    s_and_b64 exec, s[10:11], vcc
    ds_write_b32 v63, v51 offset:1024
    s_mov_b64 exec, -1
    s_waitcnt lgkmcnt(0)
    s_barrier
    ds_read_b32 v32, v6 offset:0
    ds_read_b128 v[40:43], v2 offset:1024
    ds_read_b32 v33, v6 offset:160
    ds_read_b128 v[44:47], v2 offset:6144
    ds_read_b32 v34, v6 offset:320
    ds_read_b128 v[48:51], v2 offset:11264
    ds_read_b32 v35, v6 offset:480
    ds_read_b128 v[52:55], v2 offset:16384
    ds_read_b32 v36, v6 offset:640
    ds_read_b128 v[56:59], v2 offset:21504
    ds_read_b32 v37, v6 offset:800
    ds_read_b128 v[60:63], v2 offset:26624
    ds_read_b32 v38, v6 offset:960
    ds_read_b128 v[64:67], v2 offset:31744
    s_waitcnt lgkmcnt(13)
    v_cmp_lt_u32 vcc, 32, v32
    s_waitcnt lgkmcnt(12)
    s_nop 0
    v_cndmask_b32 v40, v40, -2, vcc
    buffer_store_dwordx4 v[40:43], v28, s[48:51], s6 offen nt
    s_add_u32 s6, s6, 1638400
    s_waitcnt lgkmcnt(11)
    v_cmp_lt_u32 vcc, 32, v33
    s_waitcnt lgkmcnt(10)
    s_nop 0
    v_cndmask_b32 v44, v44, -2, vcc
    buffer_store_dwordx4 v[44:47], v28, s[48:51], s6 offen nt
    s_add_u32 s6, s6, 1638400
    s_waitcnt lgkmcnt(9)
    v_cmp_lt_u32 vcc, 32, v34
    s_waitcnt lgkmcnt(8)
    s_nop 0
    v_cndmask_b32 v48, v48, -2, vcc
    buffer_store_dwordx4 v[48:51], v28, s[48:51], s6 offen nt
    s_add_u32 s6, s6, 1638400
    s_waitcnt lgkmcnt(7)
    v_cmp_lt_u32 vcc, 32, v35
    s_waitcnt lgkmcnt(6)
    s_nop 0
    v_cndmask_b32 v52, v52, -2, vcc
    buffer_store_dwordx4 v[52:55], v28, s[48:51], s6 offen nt
    s_add_u32 s6, s6, 1638400
    s_waitcnt lgkmcnt(5)
    v_cmp_lt_u32 vcc, 32, v36
    s_waitcnt lgkmcnt(4)
    s_nop 0
    v_cndmask_b32 v56, v56, -2, vcc
    buffer_store_dwordx4 v[56:59], v28, s[48:51], s6 offen nt
    s_add_u32 s6, s6, 1638400
    s_waitcnt lgkmcnt(3)
    v_cmp_lt_u32 vcc, 32, v37
    s_waitcnt lgkmcnt(2)
    s_nop 0
    v_cndmask_b32 v60, v60, -2, vcc
    buffer_store_dwordx4 v[60:63], v28, s[48:51], s6 offen nt
    s_add_u32 s6, s6, 1638400
    s_cmp_ge_u32 s3, 2
    s_cbranch_scc1 P1_FIN
    s_waitcnt lgkmcnt(1)
    v_cmp_lt_u32 vcc, 32, v38
    s_waitcnt lgkmcnt(0)
    s_nop 0
    v_cndmask_b32 v64, v64, -2, vcc
    buffer_store_dwordx4 v[64:67], v28, s[48:51], s6 offen nt
    s_add_u32 s6, s6, 1638400
P1_FIN:
    s_endpgm
P1_AUX:
    v_and_b32 v24, 31, v1
    v_lshrrev_b32 v25, 5, v1
    v_lshlrev_b32 v26, 10, v25
    v_lshl_add_u32 v26, v24, 1, v26
    s_mov_b32 s14, 1.0
    s_waitcnt lgkmcnt(0)
    s_mov_b32 s48, s34
    s_mov_b32 s49, s35
    s_mov_b32 s50, 50331648
    s_mov_b32 s51, 0x20000
    s_mov_b32 s56, s28
    s_mov_b32 s57, s29
    s_mov_b32 s58, 1984
    s_mov_b32 s59, 0x20000
    s_cmp_ge_u32 s2, 44
    s_cbranch_scc1 P1_PF
    s_mov_b32 s13, s2
    s_mov_b32 s15, 3216550459
    s_cmp_lt_u32 s2, 34
    s_cbranch_scc1 P1_FL0
    s_mov_b32 s15, 1.0
    s_sub_u32 s13, s2, 34
    s_sub_u32 s5, s2, 26
    s_cmp_ge_u32 s2, 42
    s_cselect_b32 s13, s5, s13
P1_FL0:
    s_sub_u32 s5, s13, 2
    s_cmp_ge_u32 s13, 18
    s_cselect_b32 s5, s5, s13
    s_and_b32 s6, s5, 3
    s_lshl_b32 s6, s6, 11
    s_lshr_b32 s7, s5, 2
    s_and_b32 s7, s7, 1
    s_lshl_b32 s7, s7, 6
    s_add_u32 s6, s6, s7
    s_cmp_ge_u32 s13, 8
    s_cbranch_scc1 P1_FL1
    s_add_u32 s6, s6, 8192
    s_mov_b32 s14, s15
    s_branch P1_FL3
P1_FL1:
    s_cmp_ge_u32 s13, 16
    s_cbranch_scc1 P1_FL2
    s_mov_b32 s56, s26
    s_mov_b32 s57, s27
    s_branch P1_FL3
P1_FL2:
    s_cmp_ge_u32 s13, 26
    s_cselect_b32 s56, s24, s28
    s_cselect_b32 s57, s25, s29
    s_cmp_ge_u32 s13, 18
    s_cbranch_scc1 P1_FL3
    s_mov_b32 s14, s15
    s_and_b32 s6, s13, 1
    s_lshl_b32 s6, s6, 6
    s_add_u32 s6, s6, 16384
P1_FL3:
    s_add_u32 s56, s56, s6
    s_addc_u32 s57, s57, 0
    buffer_load_ushort v40, v26, s[56:59], 0 offen offset:0
    buffer_load_ushort v41, v26, s[56:59], 0 offen offset:128
    buffer_load_ushort v42, v26, s[56:59], 0 offen offset:256
    buffer_load_ushort v43, v26, s[56:59], 0 offen offset:384
    buffer_load_ushort v44, v26, s[56:59], 0 offen offset:512
    buffer_load_ushort v45, v26, s[56:59], 0 offen offset:640
    buffer_load_ushort v46, v26, s[56:59], 0 offen offset:768
    buffer_load_ushort v47, v26, s[56:59], 0 offen offset:896
    s_waitcnt vmcnt(0)
    v_lshlrev_b32 v40, 16, v40
    v_lshlrev_b32 v41, 16, v41
    v_lshlrev_b32 v42, 16, v42
    v_lshlrev_b32 v43, 16, v43
    v_lshlrev_b32 v44, 16, v44
    v_lshlrev_b32 v45, 16, v45
    v_lshlrev_b32 v46, 16, v46
    v_lshlrev_b32 v47, 16, v47
    v_mul_f32 v40, s14, v40
    v_mul_f32 v41, s14, v41
    v_mul_f32 v42, s14, v42
    v_mul_f32 v43, s14, v43
    v_mul_f32 v44, s14, v44
    v_mul_f32 v45, s14, v45
    v_mul_f32 v46, s14, v46
    v_mul_f32 v47, s14, v47
    v_cvt_pk_bf16_f32 v48, v40, v41
    v_cvt_pk_bf16_f32 v49, v42, v43
    v_cvt_pk_bf16_f32 v50, v44, v45
    v_cvt_pk_bf16_f32 v51, v46, v47
    s_lshl_b32 s6, s2, 10
    s_add_u32 s6, s6, 15204352
    buffer_store_dwordx4 v[48:51], v4, s[48:51], s6 offen
    s_endpgm
P1_PF:
    s_cmp_ge_u32 s2, 80
    s_cbranch_scc1 P1_XM
    s_getpc_b64 s[52:53]
P1_PC:
    s_add_u32 s52, s52, p2_kernel-P1_PC
    s_addc_u32 s53, s53, 0
    s_mov_b32 s54, P2_END-p2_kernel
    s_mov_b32 s55, 0x20000
    v_lshlrev_b32 v40, 6, v1
    buffer_load_dword v41, v40, s[52:55], 0 offen
    v_add_u32 v40, 0x1000, v40
    buffer_load_dword v41, v40, s[52:55], 0 offen
    v_add_u32 v40, 0x1000, v40
    buffer_load_dword v41, v40, s[52:55], 0 offen
    v_add_u32 v40, 0x1000, v40
    buffer_load_dword v41, v40, s[52:55], 0 offen
    v_add_u32 v40, 0x1000, v40
    buffer_load_dword v41, v40, s[52:55], 0 offen
    v_add_u32 v40, 0x1000, v40
    buffer_load_dword v41, v40, s[52:55], 0 offen
    v_add_u32 v40, 0x1000, v40
    s_endpgm
P1_XM:
    s_mov_b32 s36, s16
    s_mov_b32 s37, s17
    s_mov_b32 s38, 1600000
    s_mov_b32 s39, 0x20000
    s_sub_u32 s5, s2, 80
    s_lshl_b32 s5, s5, 13
    v_lshlrev_b32 v40, 7, v1
    buffer_load_dword v41, v40, s[36:39], s5 offen
P1_END:
    s_endpgm
.globl p2_kernel
.p2align 8
.type p2_kernel,@function
p2_kernel:
    s_cmp_ge_u32 s2, 256
    s_cbranch_scc1 P2_END
    s_getpc_b64 s[52:53]
P2_PC:
    s_mov_b32 s54, P2_END-P2_PC
    s_mov_b32 s55, 0x20000
    v_lshlrev_b32 v28, 7, v0
    buffer_load_dword v29, v28, s[52:55], 0 offen
    s_load_dwordx4 s[16:19], s[0:1], 0
    s_load_dwordx4 s[28:31], s[0:1], 16
    s_load_dwordx2 s[12:13], s[0:1], 56
    s_load_dwordx2 s[34:35], s[0:1], 72
    s_and_b32 s4, s2, 7
    s_lshl_b32 s4, s4, 5
    s_lshr_b32 s5, s2, 3
    s_add_u32 s4, s4, s5
    v_and_b32 v1, 63, v0
    v_lshrrev_b32 v5, 6, v0
    v_lshlrev_b32 v3, 4, v0
    v_lshlrev_b32 v4, 2, v0
    v_readfirstlane_b32 s3, v5
    s_mul_i32 s8, s4, 40960
    s_add_u32 s8, s8, 0
    s_mul_i32 s6, s4, 6272
    v_and_b32 v56, 31, v1
    v_lshrrev_b32 v57, 5, v1
    v_and_b32 v58, 7, v1
    v_lshlrev_b32 v59, 2, v57
    v_xor_b32 v58, v58, v59
    v_lshlrev_b32 v180, 4, v58
    s_waitcnt lgkmcnt(0)
    s_mov_b32 s40, s34
    s_mov_b32 s41, s35
    s_mov_b32 s42, 50331648
    s_mov_b32 s43, 0x20000
    buffer_load_dwordx4 v[64:67], v3, s[40:43], s8 offen
    s_add_u32 s8, s8, 8192
    buffer_load_dwordx4 v[68:71], v3, s[40:43], s8 offen
    s_add_u32 s8, s8, 8192
    buffer_load_dwordx4 v[72:75], v3, s[40:43], s8 offen
    s_add_u32 s8, s8, 8192
    buffer_load_dwordx4 v[76:79], v3, s[40:43], s8 offen
    s_add_u32 s8, s8, 8192
    buffer_load_dwordx4 v[80:83], v3, s[40:43], s8 offen
    s_add_u32 s8, s8, 8192
    s_mov_b32 s36, s16
    s_mov_b32 s37, s17
    s_mov_b32 s38, 1600000
    s_mov_b32 s39, 0x20000
    s_mov_b32 s56, s18
    s_mov_b32 s57, s19
    s_mov_b32 s58, 25600000
    s_mov_b32 s59, 0x20000
    s_add_u32 s44, s12, s6
    s_addc_u32 s45, s13, 0
    s_sub_u32 s46, 1600000, s6
    s_min_u32 s46, s46, 6272
    s_mov_b32 s47, 0x20000
    s_mov_b32 s19, 1600000
    s_mov_b32 s18, 25600000
    s_lshl_b32 s20, s3, 13
    s_add_u32 s20, s20, 72704
    v_lshlrev_b32 v181, 3, v56
    v_lshlrev_b32 v182, 4, v57
    v_lshrrev_b32 v58, 5, v0
    v_lshl_add_u32 v183, v58, 8, v181
    v_xor_b32 v10, 16, v180
    v_xor_b32 v11, 32, v180
    v_xor_b32 v12, 48, v180
    v_and_b32 v58, 3, v56
    v_lshrrev_b32 v59, 2, v56
    v_lshl_add_u32 v59, v58, 3, v59
    v_lshlrev_b32 v59, 7, v59
    v_add_u32 v59, s20, v59
    v_lshrrev_b32 v60, 4, v56
    v_lshl_add_u32 v58, v60, 2, v58
    v_xor_b32 v58, v58, v57
    v_xor_b32 v60, 0, v58
    v_lshl_add_u32 v172, v60, 4, v59
    v_xor_b32 v60, 2, v58
    v_lshl_add_u32 v173, v60, 4, v59
    v_xor_b32 v60, 4, v58
    v_lshl_add_u32 v174, v60, 4, v59
    v_xor_b32 v60, 6, v58
    v_lshl_add_u32 v175, v60, 4, v59
    v_mov_b32 v16, 0
    v_mov_b32 v17, 0
    v_mov_b32 v18, 0
    v_mov_b32 v19, 0
    v_mov_b32 v20, 0
    v_mov_b32 v21, 0
    v_mov_b32 v22, 0
    v_mov_b32 v23, 0
    ds_write_b32 v16, v16 offset:256
    s_mov_b32 s23, 0
    s_mov_b32 s24, 0
    s_mov_b32 s25, 0
    s_mov_b32 s15, 0
P2_ROUND:
    v_mov_b32 v32, 1073741824
    v_mov_b32 v33, 1073741824
    v_mov_b32 v34, 1073741824
    v_mov_b32 v35, 1073741824
    ds_write_b128 v3, v[32:35] offset:512
    ds_write_b128 v3, v[32:35] offset:8704
    ds_write_b128 v3, v[32:35] offset:16896
    ds_write_b128 v3, v[32:35] offset:25088
    v_mov_b32 v36, 12544
    v_mov_b32 v37, 12544
    v_lshlrev_b32 v40, 3, v0
    ds_write_b64 v40, v[36:37] offset:33280
    v_mov_b32 v38, -1
    v_mov_b32 v39, -1
    ds_write_b64 v40, v[38:39] offset:37376
    v_mov_b32 v41, 0
    v_and_b32 v42, 0xfc, v4
    ds_write_b32 v42, v41 offset:0
    v_mov_b32 v43, 1
    s_cmp_lg_u32 s24, 0
    s_cbranch_scc1 P2_SLOW
    v_lshrrev_b32 v44, 3, v0
    v_mul_u32_u24 v13, 2500, v44
    s_waitcnt lgkmcnt(0)
    s_barrier
    s_waitcnt vmcnt(4)
    v_cmp_eq_u32 vcc, -2, v64
    s_cbranch_vccz P2_NOOVF0
    ds_or_b32 v41, v43 offset:256
    s_branch P2_A_LD
P2_NOOVF0:
    v_cmpx_ne_u32 vcc, -1, v64
    v_bfe_u32 v124, v64, 14, 6
    v_lshlrev_b32 v124, 2, v124
    ds_add_rtn_u32 v104, v124, v43 offset:0
    v_lshrrev_b32 v84, 20, v64
    v_add_lshl_u32 v84, v84, v13, 5
    v_and_b32 v144, 0x3fff, v64
    v_lshlrev_b32 v144, 7, v144
    v_cmpx_ne_u32 vcc, -1, v65
    v_bfe_u32 v125, v65, 14, 6
    v_lshlrev_b32 v125, 2, v125
    ds_add_rtn_u32 v105, v125, v43 offset:0
    v_lshrrev_b32 v85, 20, v65
    v_add_lshl_u32 v85, v85, v13, 5
    v_and_b32 v145, 0x3fff, v65
    v_lshlrev_b32 v145, 7, v145
    v_cmpx_ne_u32 vcc, -1, v66
    s_cbranch_execz P2_A0
    v_bfe_u32 v126, v66, 14, 6
    v_lshlrev_b32 v126, 2, v126
    ds_add_rtn_u32 v106, v126, v43 offset:0
    v_lshrrev_b32 v86, 20, v66
    v_add_lshl_u32 v86, v86, v13, 5
    v_and_b32 v146, 0x3fff, v66
    v_lshlrev_b32 v146, 7, v146
    v_cmpx_ne_u32 vcc, -1, v67
    s_cbranch_execz P2_A0
    v_bfe_u32 v127, v67, 14, 6
    v_lshlrev_b32 v127, 2, v127
    ds_add_rtn_u32 v107, v127, v43 offset:0
    v_lshrrev_b32 v87, 20, v67
    v_add_lshl_u32 v87, v87, v13, 5
    v_and_b32 v147, 0x3fff, v67
    v_lshlrev_b32 v147, 7, v147
P2_A0:
    s_mov_b64 exec, -1
    v_add_u32 v13, 160000, v13
    s_waitcnt vmcnt(3)
    v_cmp_eq_u32 vcc, -2, v68
    s_cbranch_vccz P2_NOOVF1
    ds_or_b32 v41, v43 offset:256
    s_branch P2_A_LD
P2_NOOVF1:
    v_cmpx_ne_u32 vcc, -1, v68
    v_bfe_u32 v128, v68, 14, 6
    v_lshlrev_b32 v128, 2, v128
    ds_add_rtn_u32 v108, v128, v43 offset:0
    v_lshrrev_b32 v88, 20, v68
    v_add_lshl_u32 v88, v88, v13, 5
    v_and_b32 v148, 0x3fff, v68
    v_lshlrev_b32 v148, 7, v148
    v_cmpx_ne_u32 vcc, -1, v69
    v_bfe_u32 v129, v69, 14, 6
    v_lshlrev_b32 v129, 2, v129
    ds_add_rtn_u32 v109, v129, v43 offset:0
    v_lshrrev_b32 v89, 20, v69
    v_add_lshl_u32 v89, v89, v13, 5
    v_and_b32 v149, 0x3fff, v69
    v_lshlrev_b32 v149, 7, v149
    v_cmpx_ne_u32 vcc, -1, v70
    s_cbranch_execz P2_A1
    v_bfe_u32 v130, v70, 14, 6
    v_lshlrev_b32 v130, 2, v130
    ds_add_rtn_u32 v110, v130, v43 offset:0
    v_lshrrev_b32 v90, 20, v70
    v_add_lshl_u32 v90, v90, v13, 5
    v_and_b32 v150, 0x3fff, v70
    v_lshlrev_b32 v150, 7, v150
    v_cmpx_ne_u32 vcc, -1, v71
    s_cbranch_execz P2_A1
    v_bfe_u32 v131, v71, 14, 6
    v_lshlrev_b32 v131, 2, v131
    ds_add_rtn_u32 v111, v131, v43 offset:0
    v_lshrrev_b32 v91, 20, v71
    v_add_lshl_u32 v91, v91, v13, 5
    v_and_b32 v151, 0x3fff, v71
    v_lshlrev_b32 v151, 7, v151
P2_A1:
    s_mov_b64 exec, -1
    v_add_u32 v13, 160000, v13
    s_waitcnt vmcnt(2)
    v_cmp_eq_u32 vcc, -2, v72
    s_cbranch_vccz P2_NOOVF2
    ds_or_b32 v41, v43 offset:256
    s_branch P2_A_LD
P2_NOOVF2:
    v_cmpx_ne_u32 vcc, -1, v72
    v_bfe_u32 v132, v72, 14, 6
    v_lshlrev_b32 v132, 2, v132
    ds_add_rtn_u32 v112, v132, v43 offset:0
    v_lshrrev_b32 v92, 20, v72
    v_add_lshl_u32 v92, v92, v13, 5
    v_and_b32 v152, 0x3fff, v72
    v_lshlrev_b32 v152, 7, v152
    v_cmpx_ne_u32 vcc, -1, v73
    v_bfe_u32 v133, v73, 14, 6
    v_lshlrev_b32 v133, 2, v133
    ds_add_rtn_u32 v113, v133, v43 offset:0
    v_lshrrev_b32 v93, 20, v73
    v_add_lshl_u32 v93, v93, v13, 5
    v_and_b32 v153, 0x3fff, v73
    v_lshlrev_b32 v153, 7, v153
    v_cmpx_ne_u32 vcc, -1, v74
    s_cbranch_execz P2_A2
    v_bfe_u32 v134, v74, 14, 6
    v_lshlrev_b32 v134, 2, v134
    ds_add_rtn_u32 v114, v134, v43 offset:0
    v_lshrrev_b32 v94, 20, v74
    v_add_lshl_u32 v94, v94, v13, 5
    v_and_b32 v154, 0x3fff, v74
    v_lshlrev_b32 v154, 7, v154
    v_cmpx_ne_u32 vcc, -1, v75
    s_cbranch_execz P2_A2
    v_bfe_u32 v135, v75, 14, 6
    v_lshlrev_b32 v135, 2, v135
    ds_add_rtn_u32 v115, v135, v43 offset:0
    v_lshrrev_b32 v95, 20, v75
    v_add_lshl_u32 v95, v95, v13, 5
    v_and_b32 v155, 0x3fff, v75
    v_lshlrev_b32 v155, 7, v155
P2_A2:
    s_mov_b64 exec, -1
    v_add_u32 v13, 160000, v13
    s_waitcnt vmcnt(1)
    v_cmp_eq_u32 vcc, -2, v76
    s_cbranch_vccz P2_NOOVF3
    ds_or_b32 v41, v43 offset:256
    s_branch P2_A_LD
P2_NOOVF3:
    v_cmpx_ne_u32 vcc, -1, v76
    v_bfe_u32 v136, v76, 14, 6
    v_lshlrev_b32 v136, 2, v136
    ds_add_rtn_u32 v116, v136, v43 offset:0
    v_lshrrev_b32 v96, 20, v76
    v_add_lshl_u32 v96, v96, v13, 5
    v_and_b32 v156, 0x3fff, v76
    v_lshlrev_b32 v156, 7, v156
    v_cmpx_ne_u32 vcc, -1, v77
    v_bfe_u32 v137, v77, 14, 6
    v_lshlrev_b32 v137, 2, v137
    ds_add_rtn_u32 v117, v137, v43 offset:0
    v_lshrrev_b32 v97, 20, v77
    v_add_lshl_u32 v97, v97, v13, 5
    v_and_b32 v157, 0x3fff, v77
    v_lshlrev_b32 v157, 7, v157
    v_cmpx_ne_u32 vcc, -1, v78
    s_cbranch_execz P2_A3
    v_bfe_u32 v138, v78, 14, 6
    v_lshlrev_b32 v138, 2, v138
    ds_add_rtn_u32 v118, v138, v43 offset:0
    v_lshrrev_b32 v98, 20, v78
    v_add_lshl_u32 v98, v98, v13, 5
    v_and_b32 v158, 0x3fff, v78
    v_lshlrev_b32 v158, 7, v158
    v_cmpx_ne_u32 vcc, -1, v79
    s_cbranch_execz P2_A3
    v_bfe_u32 v139, v79, 14, 6
    v_lshlrev_b32 v139, 2, v139
    ds_add_rtn_u32 v119, v139, v43 offset:0
    v_lshrrev_b32 v99, 20, v79
    v_add_lshl_u32 v99, v99, v13, 5
    v_and_b32 v159, 0x3fff, v79
    v_lshlrev_b32 v159, 7, v159
P2_A3:
    s_mov_b64 exec, -1
    v_add_u32 v13, 160000, v13
    s_waitcnt vmcnt(0)
    v_cmp_eq_u32 vcc, -2, v80
    s_cbranch_vccz P2_NOOVF4
    ds_or_b32 v41, v43 offset:256
    s_branch P2_A_LD
P2_NOOVF4:
    v_cmpx_ne_u32 vcc, -1, v80
    v_bfe_u32 v140, v80, 14, 6
    v_lshlrev_b32 v140, 2, v140
    ds_add_rtn_u32 v120, v140, v43 offset:0
    v_lshrrev_b32 v100, 20, v80
    v_add_lshl_u32 v100, v100, v13, 5
    v_and_b32 v160, 0x3fff, v80
    v_lshlrev_b32 v160, 7, v160
    v_cmpx_ne_u32 vcc, -1, v81
    v_bfe_u32 v141, v81, 14, 6
    v_lshlrev_b32 v141, 2, v141
    ds_add_rtn_u32 v121, v141, v43 offset:0
    v_lshrrev_b32 v101, 20, v81
    v_add_lshl_u32 v101, v101, v13, 5
    v_and_b32 v161, 0x3fff, v81
    v_lshlrev_b32 v161, 7, v161
    v_cmpx_ne_u32 vcc, -1, v82
    s_cbranch_execz P2_A4
    v_bfe_u32 v142, v82, 14, 6
    v_lshlrev_b32 v142, 2, v142
    ds_add_rtn_u32 v122, v142, v43 offset:0
    v_lshrrev_b32 v102, 20, v82
    v_add_lshl_u32 v102, v102, v13, 5
    v_and_b32 v162, 0x3fff, v82
    v_lshlrev_b32 v162, 7, v162
    v_cmpx_ne_u32 vcc, -1, v83
    s_cbranch_execz P2_A4
    v_bfe_u32 v143, v83, 14, 6
    v_lshlrev_b32 v143, 2, v143
    ds_add_rtn_u32 v123, v143, v43 offset:0
    v_lshrrev_b32 v103, 20, v83
    v_add_lshl_u32 v103, v103, v13, 5
    v_and_b32 v163, 0x3fff, v83
    v_lshlrev_b32 v163, 7, v163
P2_A4:
    s_mov_b64 exec, -1
    v_add_u32 v13, 160000, v13
P2_A_LD:
    s_mov_b64 exec, -1
    s_and_b32 s9, s3, 3
    s_lshl_b32 s10, s9, 4
    v_xor_b32 v26, s10, v180
    v_lshrrev_b32 v27, 3, v1
    v_lshl_add_u32 v26, v27, 9, v26
    s_lshr_b32 s10, s3, 2
    s_lshl_b32 s10, s10, 12
    s_lshl_b32 s11, s9, 7
    s_add_u32 s10, s10, s11
    s_add_u32 s10, s10, s6
    s_lshl_b32 s11, s3, 10
    s_add_u32 m0, s11, 151040
    v_lshlrev_b32 v27, 4, v1
    buffer_load_dwordx4 v26, s[36:39], s10 offen lds
    s_add_u32 m0, s11, 54272
    s_add_u32 s10, s11, 15204352
    buffer_load_dwordx4 v27, s[40:43], s10 offen lds
    s_add_u32 m0, s11, 62464
    s_add_u32 s10, s11, 15212544
    buffer_load_dwordx4 v27, s[40:43], s10 offen lds
    s_and_b32 s11, s11, 0x400
    s_add_u32 m0, s11, 70656
    s_add_u32 s10, s11, 15220736
    buffer_load_dwordx4 v27, s[40:43], s10 offen lds
    s_lshl_b32 s9, s9, 12
    s_add_u32 s9, s9, 15222784
    buffer_load_dwordx4 v[200:203], v27, s[40:43], s9 offen offset:0
    buffer_load_dwordx4 v[204:207], v27, s[40:43], s9 offen offset:1024
    buffer_load_dwordx4 v[208:211], v27, s[40:43], s9 offen offset:2048
    buffer_load_dwordx4 v[212:215], v27, s[40:43], s9 offen offset:3072
    s_branch P2_A_DONE
P2_SLOW:
    s_mov_b32 s48, s30
    s_mov_b32 s49, s31
    s_mov_b32 s50, 3200000
    s_mov_b32 s51, 0x20000
    s_mov_b32 s52, s28
    s_mov_b32 s53, s29
    s_mov_b32 s54, 3200000
    s_mov_b32 s55, 0x20000
    ds_write_b32 v41, v41 offset:272
    s_mul_i32 s26, s4, 49
    v_mov_b32 v13, 72704
    s_waitcnt lgkmcnt(0)
    s_barrier
P2_SCAN:
    s_lshl_b32 s10, s23, 2
    v_add_u32 v45, s23, v0
    buffer_load_dword v44, v4, s[48:51], s10 offen
    v_cmp_gt_u32 vcc, 800000, v45
    s_mov_b64 s[10:11], vcc
    s_waitcnt vmcnt(0)
    v_subrev_u32 v44, s26, v44
    v_cmp_gt_u32 vcc, 49, v44
    s_and_b64 exec, vcc, s[10:11]
    ds_add_rtn_u32 v46, v41, v43 offset:272
    s_waitcnt lgkmcnt(0)
    v_lshl_add_u32 v46, v46, 2, v13
    ds_write_b32 v46, v45
    s_mov_b64 exec, -1
    s_add_u32 s23, s23, 512
    s_waitcnt lgkmcnt(0)
    s_barrier
    ds_read_b32 v46, v41 offset:272
    s_waitcnt lgkmcnt(0)
    v_readfirstlane_b32 s27, v46
    s_barrier
    s_cmp_gt_u32 s27, 3072
    s_cbranch_scc1 P2_SCAN_DONE
    s_cmp_lt_u32 s23, 800000
    s_cbranch_scc1 P2_SCAN
P2_SCAN_DONE:
    v_mov_b32 v64, -1
    v_mov_b32 v65, -1
    v_mov_b32 v66, -1
    v_mov_b32 v67, -1
    v_mov_b32 v68, -1
    v_mov_b32 v69, -1
    v_mov_b32 v70, -1
    v_mov_b32 v71, -1
    v_mov_b32 v72, -1
    v_mov_b32 v73, -1
    v_mov_b32 v74, -1
    v_mov_b32 v75, -1
    v_mov_b32 v76, -1
    v_mov_b32 v77, -1
    v_mov_b32 v78, -1
    v_mov_b32 v79, -1
    v_mov_b32 v80, -1
    v_mov_b32 v81, -1
    v_mov_b32 v82, -1
    v_mov_b32 v83, -1
    v_add_u32 v47, 72704, v4
    v_add_u32 v44, 0, v0
    v_cmp_gt_u32 vcc, s27, v44
    s_and_saveexec_b64 s[10:11], vcc
    s_cbranch_execz P2_A_DONE
    ds_read_b32 v45, v47 offset:0
    s_waitcnt lgkmcnt(0)
    v_lshlrev_b32 v46, 2, v45
    buffer_load_dword v124, v46, s[48:51], 0 offen
    buffer_load_dword v144, v46, s[52:55], 0 offen
    v_lshlrev_b32 v84, 5, v45
    v_mov_b32 v64, 0
    s_waitcnt vmcnt(0)
    v_subrev_u32 v124, s26, v124
    v_lshlrev_b32 v124, 2, v124
    ds_add_rtn_u32 v104, v124, v43 offset:0
    v_lshlrev_b32 v144, 7, v144
    v_add_u32 v44, 512, v0
    v_cmp_gt_u32 vcc, s27, v44
    s_and_saveexec_b64 s[10:11], vcc
    s_cbranch_execz P2_A_DONE
    ds_read_b32 v45, v47 offset:2048
    s_waitcnt lgkmcnt(0)
    v_lshlrev_b32 v46, 2, v45
    buffer_load_dword v125, v46, s[48:51], 0 offen
    buffer_load_dword v145, v46, s[52:55], 0 offen
    v_lshlrev_b32 v85, 5, v45
    v_mov_b32 v65, 0
    s_waitcnt vmcnt(0)
    v_subrev_u32 v125, s26, v125
    v_lshlrev_b32 v125, 2, v125
    ds_add_rtn_u32 v105, v125, v43 offset:0
    v_lshlrev_b32 v145, 7, v145
    v_add_u32 v44, 1024, v0
    v_cmp_gt_u32 vcc, s27, v44
    s_and_saveexec_b64 s[10:11], vcc
    s_cbranch_execz P2_A_DONE
    ds_read_b32 v45, v47 offset:4096
    s_waitcnt lgkmcnt(0)
    v_lshlrev_b32 v46, 2, v45
    buffer_load_dword v126, v46, s[48:51], 0 offen
    buffer_load_dword v146, v46, s[52:55], 0 offen
    v_lshlrev_b32 v86, 5, v45
    v_mov_b32 v66, 0
    s_waitcnt vmcnt(0)
    v_subrev_u32 v126, s26, v126
    v_lshlrev_b32 v126, 2, v126
    ds_add_rtn_u32 v106, v126, v43 offset:0
    v_lshlrev_b32 v146, 7, v146
    v_add_u32 v44, 1536, v0
    v_cmp_gt_u32 vcc, s27, v44
    s_and_saveexec_b64 s[10:11], vcc
    s_cbranch_execz P2_A_DONE
    ds_read_b32 v45, v47 offset:6144
    s_waitcnt lgkmcnt(0)
    v_lshlrev_b32 v46, 2, v45
    buffer_load_dword v127, v46, s[48:51], 0 offen
    buffer_load_dword v147, v46, s[52:55], 0 offen
    v_lshlrev_b32 v87, 5, v45
    v_mov_b32 v67, 0
    s_waitcnt vmcnt(0)
    v_subrev_u32 v127, s26, v127
    v_lshlrev_b32 v127, 2, v127
    ds_add_rtn_u32 v107, v127, v43 offset:0
    v_lshlrev_b32 v147, 7, v147
    v_add_u32 v44, 2048, v0
    v_cmp_gt_u32 vcc, s27, v44
    s_and_saveexec_b64 s[10:11], vcc
    s_cbranch_execz P2_A_DONE
    ds_read_b32 v45, v47 offset:8192
    s_waitcnt lgkmcnt(0)
    v_lshlrev_b32 v46, 2, v45
    buffer_load_dword v128, v46, s[48:51], 0 offen
    buffer_load_dword v148, v46, s[52:55], 0 offen
    v_lshlrev_b32 v88, 5, v45
    v_mov_b32 v68, 0
    s_waitcnt vmcnt(0)
    v_subrev_u32 v128, s26, v128
    v_lshlrev_b32 v128, 2, v128
    ds_add_rtn_u32 v108, v128, v43 offset:0
    v_lshlrev_b32 v148, 7, v148
    v_add_u32 v44, 2560, v0
    v_cmp_gt_u32 vcc, s27, v44
    s_and_saveexec_b64 s[10:11], vcc
    s_cbranch_execz P2_A_DONE
    ds_read_b32 v45, v47 offset:10240
    s_waitcnt lgkmcnt(0)
    v_lshlrev_b32 v46, 2, v45
    buffer_load_dword v129, v46, s[48:51], 0 offen
    buffer_load_dword v149, v46, s[52:55], 0 offen
    v_lshlrev_b32 v89, 5, v45
    v_mov_b32 v69, 0
    s_waitcnt vmcnt(0)
    v_subrev_u32 v129, s26, v129
    v_lshlrev_b32 v129, 2, v129
    ds_add_rtn_u32 v109, v129, v43 offset:0
    v_lshlrev_b32 v149, 7, v149
    v_add_u32 v44, 3072, v0
    v_cmp_gt_u32 vcc, s27, v44
    s_and_saveexec_b64 s[10:11], vcc
    s_cbranch_execz P2_A_DONE
    ds_read_b32 v45, v47 offset:12288
    s_waitcnt lgkmcnt(0)
    v_lshlrev_b32 v46, 2, v45
    buffer_load_dword v130, v46, s[48:51], 0 offen
    buffer_load_dword v150, v46, s[52:55], 0 offen
    v_lshlrev_b32 v90, 5, v45
    v_mov_b32 v70, 0
    s_waitcnt vmcnt(0)
    v_subrev_u32 v130, s26, v130
    v_lshlrev_b32 v130, 2, v130
    ds_add_rtn_u32 v110, v130, v43 offset:0
    v_lshlrev_b32 v150, 7, v150
P2_A_DONE:
    s_mov_b64 exec, -1
    v_lshlrev_b32 v44, 2, v1
    s_waitcnt lgkmcnt(0)
    s_barrier
    ds_read_b32 v45, v44 offset:0
    ds_read_b32 v47, v41 offset:256
    s_waitcnt lgkmcnt(0)
    v_add_u32 v32, 3, v45
    v_and_b32 v32, -4, v32
    v_mov_b32 v33, v32
    v_readfirstlane_b32 s14, v47
    s_nop 1
    v_add_u32_dpp v33, v33, v33 row_shr:1 row_mask:0xf bank_mask:0xf bound_ctrl:0
    s_nop 1
    v_add_u32_dpp v33, v33, v33 row_shr:2 row_mask:0xf bank_mask:0xf bound_ctrl:0
    s_nop 1
    v_add_u32_dpp v33, v33, v33 row_shr:4 row_mask:0xf bank_mask:0xf bound_ctrl:0
    s_nop 1
    v_add_u32_dpp v33, v33, v33 row_shr:8 row_mask:0xf bank_mask:0xf bound_ctrl:0
    s_nop 1
    v_add_u32_dpp v33, v33, v33 row_bcast:15 row_mask:0xa bank_mask:0xf
    s_nop 1
    v_add_u32_dpp v33, v33, v33 row_bcast:31 row_mask:0xc bank_mask:0xf
    s_nop 0
    v_readlane_b32 s12, v33, 63
    v_add_u32 v34, -1, v33
    v_sub_u32 v33, v33, v32
    s_cmp_lg_u32 s24, 0
    s_cbranch_scc1 P2_CHK_DONE
    s_and_b32 s14, s14, 1
    s_cmp_gt_u32 s12, 4096
    s_cselect_b32 s14, 1, s14
    s_cmp_eq_u32 s14, 0
    s_cbranch_scc1 P2_CHK_DONE
    s_mov_b32 s24, 800000
    s_waitcnt vmcnt(0)
    s_barrier
    s_branch P2_ROUND
P2_CHK_DONE:
    ds_bpermute_b32 v124, v124, v33
    ds_bpermute_b32 v125, v125, v33
    v_cmp_ne_u32 vcc, -1, v66
    s_cbranch_vccz P2_B1_0
    ds_bpermute_b32 v126, v126, v33
    ds_bpermute_b32 v127, v127, v33
P2_B1_0:
    ds_bpermute_b32 v128, v128, v33
    ds_bpermute_b32 v129, v129, v33
    v_cmp_ne_u32 vcc, -1, v70
    s_cbranch_vccz P2_B1_1
    ds_bpermute_b32 v130, v130, v33
    ds_bpermute_b32 v131, v131, v33
P2_B1_1:
    ds_bpermute_b32 v132, v132, v33
    ds_bpermute_b32 v133, v133, v33
    v_cmp_ne_u32 vcc, -1, v74
    s_cbranch_vccz P2_B1_2
    ds_bpermute_b32 v134, v134, v33
    ds_bpermute_b32 v135, v135, v33
P2_B1_2:
    ds_bpermute_b32 v136, v136, v33
    ds_bpermute_b32 v137, v137, v33
    v_cmp_ne_u32 vcc, -1, v78
    s_cbranch_vccz P2_B1_3
    ds_bpermute_b32 v138, v138, v33
    ds_bpermute_b32 v139, v139, v33
P2_B1_3:
    ds_bpermute_b32 v140, v140, v33
    ds_bpermute_b32 v141, v141, v33
    v_cmp_ne_u32 vcc, -1, v82
    s_cbranch_vccz P2_B1_4
    ds_bpermute_b32 v142, v142, v33
    ds_bpermute_b32 v143, v143, v33
P2_B1_4:
    s_add_u32 s12, s12, 31
    s_lshr_b32 s12, s12, 5
    s_add_u32 s21, s12, 7
    s_sub_u32 s21, s21, s3
    s_lshr_b32 s21, s21, 3
    s_lshr_b32 s13, s12, 3
    s_and_b32 s14, s12, 7
    s_mul_i32 s10, s3, s13
    s_min_u32 s11, s3, s14
    s_add_u32 s10, s10, s11
    s_lshl_b32 s10, s10, 7
    s_lshl_b32 s11, s21, 6
    v_bfe_u32 v53, v1, 3, 1
    v_mul_u32_u24 v53, s11, v53
    v_lshrrev_b32 v54, 4, v1
    v_lshl_add_u32 v53, v54, 4, v53
    v_add_u32 v177, s10, v53
    v_bfe_u32 v53, v1, 2, 1
    v_mul_u32_u24 v53, s11, v53
    v_bfe_u32 v54, v1, 3, 2
    v_lshl_add_u32 v53, v54, 4, v53
    v_and_b32 v54, 3, v1
    v_lshl_add_u32 v53, v54, 2, v53
    v_add_u32 v178, s10, v53
    v_lshrrev_b32 v53, 5, v1
    v_mul_u32_u24 v53, s11, v53
    v_add_u32 v53, s10, v53
    v_lshrrev_b32 v179, 2, v53
    s_waitcnt lgkmcnt(0)
    v_cmpx_ne_u32 vcc, -1, v64
    v_add_lshl_u32 v104, v104, v124, 2
    ds_write2st64_b32 v104, v144, v84 offset0:2 offset1:66
    v_cmpx_ne_u32 vcc, -1, v65
    v_add_lshl_u32 v105, v105, v125, 2
    ds_write2st64_b32 v105, v145, v85 offset0:2 offset1:66
    v_cmpx_ne_u32 vcc, -1, v66
    s_cbranch_execz P2_B2_0
    v_add_lshl_u32 v106, v106, v126, 2
    ds_write2st64_b32 v106, v146, v86 offset0:2 offset1:66
    v_cmpx_ne_u32 vcc, -1, v67
    s_cbranch_execz P2_B2_0
    v_add_lshl_u32 v107, v107, v127, 2
    ds_write2st64_b32 v107, v147, v87 offset0:2 offset1:66
P2_B2_0:
    s_mov_b64 exec, -1
    v_cmpx_ne_u32 vcc, -1, v68
    v_add_lshl_u32 v108, v108, v128, 2
    ds_write2st64_b32 v108, v148, v88 offset0:2 offset1:66
    v_cmpx_ne_u32 vcc, -1, v69
    v_add_lshl_u32 v109, v109, v129, 2
    ds_write2st64_b32 v109, v149, v89 offset0:2 offset1:66
    v_cmpx_ne_u32 vcc, -1, v70
    s_cbranch_execz P2_B2_1
    v_add_lshl_u32 v110, v110, v130, 2
    ds_write2st64_b32 v110, v150, v90 offset0:2 offset1:66
    v_cmpx_ne_u32 vcc, -1, v71
    s_cbranch_execz P2_B2_1
    v_add_lshl_u32 v111, v111, v131, 2
    ds_write2st64_b32 v111, v151, v91 offset0:2 offset1:66
P2_B2_1:
    s_mov_b64 exec, -1
    v_cmpx_ne_u32 vcc, -1, v72
    v_add_lshl_u32 v112, v112, v132, 2
    ds_write2st64_b32 v112, v152, v92 offset0:2 offset1:66
    v_cmpx_ne_u32 vcc, -1, v73
    v_add_lshl_u32 v113, v113, v133, 2
    ds_write2st64_b32 v113, v153, v93 offset0:2 offset1:66
    v_cmpx_ne_u32 vcc, -1, v74
    s_cbranch_execz P2_B2_2
    v_add_lshl_u32 v114, v114, v134, 2
    ds_write2st64_b32 v114, v154, v94 offset0:2 offset1:66
    v_cmpx_ne_u32 vcc, -1, v75
    s_cbranch_execz P2_B2_2
    v_add_lshl_u32 v115, v115, v135, 2
    ds_write2st64_b32 v115, v155, v95 offset0:2 offset1:66
P2_B2_2:
    s_mov_b64 exec, -1
    v_cmpx_ne_u32 vcc, -1, v76
    v_add_lshl_u32 v116, v116, v136, 2
    ds_write2st64_b32 v116, v156, v96 offset0:2 offset1:66
    v_cmpx_ne_u32 vcc, -1, v77
    v_add_lshl_u32 v117, v117, v137, 2
    ds_write2st64_b32 v117, v157, v97 offset0:2 offset1:66
    v_cmpx_ne_u32 vcc, -1, v78
    s_cbranch_execz P2_B2_3
    v_add_lshl_u32 v118, v118, v138, 2
    ds_write2st64_b32 v118, v158, v98 offset0:2 offset1:66
    v_cmpx_ne_u32 vcc, -1, v79
    s_cbranch_execz P2_B2_3
    v_add_lshl_u32 v119, v119, v139, 2
    ds_write2st64_b32 v119, v159, v99 offset0:2 offset1:66
P2_B2_3:
    s_mov_b64 exec, -1
    v_cmpx_ne_u32 vcc, -1, v80
    v_add_lshl_u32 v120, v120, v140, 2
    ds_write2st64_b32 v120, v160, v100 offset0:2 offset1:66
    v_cmpx_ne_u32 vcc, -1, v81
    v_add_lshl_u32 v121, v121, v141, 2
    ds_write2st64_b32 v121, v161, v101 offset0:2 offset1:66
    v_cmpx_ne_u32 vcc, -1, v82
    s_cbranch_execz P2_B2_4
    v_add_lshl_u32 v122, v122, v142, 2
    ds_write2st64_b32 v122, v162, v102 offset0:2 offset1:66
    v_cmpx_ne_u32 vcc, -1, v83
    s_cbranch_execz P2_B2_4
    v_add_lshl_u32 v123, v123, v143, 2
    ds_write2st64_b32 v123, v163, v103 offset0:2 offset1:66
P2_B2_4:
    s_mov_b64 exec, -1
    s_waitcnt vmcnt(0) lgkmcnt(0)
    s_barrier
    ds_read_b128 v[164:167], v177 offset:512
    ds_read_b32 v60, v178 offset:16896
    ds_read_b32 v61, v178 offset:16960
    ds_read_b128 v[168:171], v177 offset:576
    s_waitcnt lgkmcnt(2)
    s_cmp_gt_u32 s21, 0
    s_cselect_b32 s58, s18, 0
    v_add_u32 v60, v60, v182
    buffer_load_dwordx4 v[144:147], v60, s[56:59], 0 offen sc1
    s_cmp_gt_u32 s21, 0
    s_cselect_b32 s38, s19, 0
    s_add_u32 m0, s20, 0
    v_or_b32 v164, v164, v180
    buffer_load_dwordx4 v164, s[36:39], 0 offen  lds
    s_add_u32 m0, s20, 1024
    v_or_b32 v165, v165, v10
    buffer_load_dwordx4 v165, s[36:39], 0 offen  lds
    s_add_u32 m0, s20, 2048
    v_or_b32 v166, v166, v11
    buffer_load_dwordx4 v166, s[36:39], 0 offen  lds
    s_add_u32 m0, s20, 3072
    v_or_b32 v167, v167, v12
    buffer_load_dwordx4 v167, s[36:39], 0 offen  lds
    ds_read_b128 v[164:167], v177 offset:640
    s_lshl_b32 s10, s3, 2
    v_add_u32 v64, s10, v33
    v_add_u32 v65, v33, v32
    v_lshlrev_b32 v66, 8, v1
    s_cmp_eq_u32 s3, 0
    s_cselect_b32 s11, 0, -1
    v_mov_b32 v67, s11
P2_G_L:
    v_cmpx_lt_u32 vcc, v64, v65
    s_cbranch_execz P2_G_DONE
    ds_write2st64_b32 v64, v66, v67 offset0:130 offset1:146
    v_add_u32 v64, 32, v64
    v_mov_b32 v67, -1
    s_branch P2_G_L
P2_G_DONE:
    s_mov_b64 exec, -1
    s_cmp_lg_u32 s25, 0
    s_cbranch_scc1 P2_PREP_A
    s_lshr_b32 s9, s3, 2
    s_lshl_b32 s10, s9, 12
    s_add_u32 s10, s10, 151040
    s_sub_u32 s10, s10, s20
    v_add_u32 v64, s10, v172
    ds_read_b128 v[216:219], v64
    v_add_u32 v65, s10, v173
    ds_read_b128 v[220:223], v65
    v_add_u32 v66, s10, v174
    ds_read_b128 v[224:227], v66
    v_add_u32 v67, s10, v175
    ds_read_b128 v[228:231], v67
    s_lshl_b32 s9, s9, 13
    s_and_b32 s10, s3, 1
    s_lshl_b32 s10, s10, 2
    s_add_u32 s9, s9, s10
    v_lshl_add_u32 v2, v182, 6, v181
    v_add_u32 v2, s9, v2
    s_waitcnt lgkmcnt(0)
    v_mfma_f32_32x32x16_bf16 v[184:199], v[216:219], v[200:203], 0
    v_mfma_f32_32x32x16_bf16 v[184:199], v[220:223], v[204:207], v[184:199]
    v_mfma_f32_32x32x16_bf16 v[184:199], v[224:227], v[208:211], v[184:199]
    v_mfma_f32_32x32x16_bf16 v[184:199], v[228:231], v[212:215], v[184:199]
P2_PREP_A:
    s_add_u32 s10, s13, 1
    s_mul_i32 s11, s14, s10
    s_lshl_b32 s11, s11, 1
    v_cvt_f32_u32 v68, s10
    v_cvt_f32_u32 v69, s13
    v_rcp_f32 v68, v68
    v_rcp_f32 v69, v69
    s_lshl_b32 s10, s14, 1
    v_lshrrev_b32 v64, 4, v33
    v_bfe_u32 v65, v34, 4, 9
    v_cmp_gt_u32 vcc, s11, v64
    v_subrev_u32 v70, s11, v64
    s_nop 0
    v_cndmask_b32 v70, v70, v64, vcc
    v_cndmask_b32 v71, v69, v68, vcc
    v_cvt_f32_u32 v70, v70
    v_add_f32 v70, 0.5, v70
    v_mul_f32 v70, v70, v71
    v_cvt_u32_f32 v70, v70
    v_add_u32 v71, s10, v70
    v_cndmask_b32 v64, v71, v70, vcc
    v_cmp_gt_u32 vcc, s11, v65
    v_subrev_u32 v70, s11, v65
    s_nop 0
    v_cndmask_b32 v70, v70, v65, vcc
    v_cndmask_b32 v71, v69, v68, vcc
    v_cvt_f32_u32 v70, v70
    v_add_f32 v70, 0.5, v70
    v_mul_f32 v70, v70, v71
    v_cvt_u32_f32 v70, v70
    v_add_u32 v71, s10, v70
    v_cndmask_b32 v65, v71, v70, vcc
    v_sub_u32 v65, v65, v64
    v_add_u32 v65, 1, v65
    v_cmp_ne_u32 vcc, 0, v32
    v_lshrrev_b32 v66, 4, v0
    v_lshlrev_b32 v66, 2, v66
    v_cndmask_b32 v65, 0, v65, vcc
    v_and_b32 v64, 15, v64
    v_lshl_or_b32 v65, v64, 8, v65
    v_add_u32 v67, 128, v66
    ds_bpermute_b32 v7, v66, v65
    ds_bpermute_b32 v8, v67, v65
    s_cmp_lg_u32 s25, 0
    s_cbranch_scc1 P2_PREP_SKIP
    s_bitcmp1_b32 s3, 1
    s_cbranch_scc1 P2_HU
    v_mul_f32 v184, 0xbfb8aa3b, v184
    v_mul_f32 v185, 0xbfb8aa3b, v185
    v_mul_f32 v186, 0xbfb8aa3b, v186
    v_mul_f32 v187, 0xbfb8aa3b, v187
    v_mul_f32 v188, 0xbfb8aa3b, v188
    v_mul_f32 v189, 0xbfb8aa3b, v189
    v_mul_f32 v190, 0xbfb8aa3b, v190
    v_mul_f32 v191, 0xbfb8aa3b, v191
    v_mul_f32 v192, 0xbfb8aa3b, v192
    v_mul_f32 v193, 0xbfb8aa3b, v193
    v_mul_f32 v194, 0xbfb8aa3b, v194
    v_mul_f32 v195, 0xbfb8aa3b, v195
    v_mul_f32 v196, 0xbfb8aa3b, v196
    v_mul_f32 v197, 0xbfb8aa3b, v197
    v_mul_f32 v198, 0xbfb8aa3b, v198
    v_mul_f32 v199, 0xbfb8aa3b, v199
    v_max3_f32 v64, abs(v184), abs(v185), abs(v186)
    v_max3_f32 v64, abs(v187), abs(v188), v64
    v_max3_f32 v64, abs(v189), abs(v190), v64
    v_max3_f32 v64, abs(v191), abs(v192), v64
    v_max3_f32 v64, abs(v193), abs(v194), v64
    v_max3_f32 v64, abs(v195), abs(v196), v64
    v_max3_f32 v64, abs(v197), abs(v198), v64
    v_max_f32 v64, abs(v199), v64
    v_mov_b32 v65, 0x41000000
    v_cmp_lt_f32 s[10:11], v65, v64
    v_cmp_u_f32 vcc, v184, v185
    s_or_b64 s[10:11], s[10:11], vcc
    v_cmp_u_f32 vcc, v186, v187
    s_or_b64 s[10:11], s[10:11], vcc
    v_cmp_u_f32 vcc, v188, v189
    s_or_b64 s[10:11], s[10:11], vcc
    v_cmp_u_f32 vcc, v190, v191
    s_or_b64 s[10:11], s[10:11], vcc
    v_cmp_u_f32 vcc, v192, v193
    s_or_b64 s[10:11], s[10:11], vcc
    v_cmp_u_f32 vcc, v194, v195
    s_or_b64 s[10:11], s[10:11], vcc
    v_cmp_u_f32 vcc, v196, v197
    s_or_b64 s[10:11], s[10:11], vcc
    v_cmp_u_f32 vcc, v198, v199
    s_or_b64 s[10:11], s[10:11], vcc
    s_cmp_eq_u64 s[10:11], 0
    s_cbranch_scc1 P2_EA_W
    v_mov_b32 v65, 2
    ds_or_b32 v41, v65 offset:256
    s_branch P2_EA_W
P2_HU:
    v_add_u32 v2, 138240, v2
    v_cvt_pk_bf16_f32 v184, v184, v184
    v_cvt_pk_bf16_f32 v185, v185, v185
    v_cvt_pk_bf16_f32 v186, v186, v186
    v_cvt_pk_bf16_f32 v187, v187, v187
    v_cvt_pk_bf16_f32 v188, v188, v188
    v_cvt_pk_bf16_f32 v189, v189, v189
    v_cvt_pk_bf16_f32 v190, v190, v190
    v_cvt_pk_bf16_f32 v191, v191, v191
    v_cvt_pk_bf16_f32 v192, v192, v192
    v_cvt_pk_bf16_f32 v193, v193, v193
    v_cvt_pk_bf16_f32 v194, v194, v194
    v_cvt_pk_bf16_f32 v195, v195, v195
    v_cvt_pk_bf16_f32 v196, v196, v196
    v_cvt_pk_bf16_f32 v197, v197, v197
    v_cvt_pk_bf16_f32 v198, v198, v198
    v_cvt_pk_bf16_f32 v199, v199, v199
    v_and_b32 v184, 0xffff0000, v184
    v_and_b32 v185, 0xffff0000, v185
    v_and_b32 v186, 0xffff0000, v186
    v_and_b32 v187, 0xffff0000, v187
    v_and_b32 v188, 0xffff0000, v188
    v_and_b32 v189, 0xffff0000, v189
    v_and_b32 v190, 0xffff0000, v190
    v_and_b32 v191, 0xffff0000, v191
    v_and_b32 v192, 0xffff0000, v192
    v_and_b32 v193, 0xffff0000, v193
    v_and_b32 v194, 0xffff0000, v194
    v_and_b32 v195, 0xffff0000, v195
    v_and_b32 v196, 0xffff0000, v196
    v_and_b32 v197, 0xffff0000, v197
    v_and_b32 v198, 0xffff0000, v198
    v_and_b32 v199, 0xffff0000, v199
    s_cmp_ge_u32 s3, 4
    s_cbranch_scc1 P2_DW1_0
    ds_write_b32 v2, v184 offset:0
    ds_write_b32 v2, v185 offset:256
    ds_write_b32 v2, v186 offset:512
    ds_write_b32 v2, v187 offset:768
    ds_write_b32 v2, v188 offset:2048
    ds_write_b32 v2, v189 offset:2304
    ds_write_b32 v2, v190 offset:2560
    ds_write_b32 v2, v191 offset:2816
    ds_write_b32 v2, v192 offset:4096
    ds_write_b32 v2, v193 offset:4352
    ds_write_b32 v2, v194 offset:4608
    ds_write_b32 v2, v195 offset:4864
    ds_write_b32 v2, v196 offset:6144
    ds_write_b32 v2, v197 offset:6400
    ds_write_b32 v2, v198 offset:6656
    ds_write_b32 v2, v199 offset:6912
    s_branch P2_DW2_0
P2_DW1_0:
    ds_write_b32 v2, v184 offset:0
    ds_write_b32 v2, v185 offset:256
    ds_write_b32 v2, v186 offset:512
    ds_write_b32 v2, v187 offset:768
    ds_write_b32 v2, v188 offset:2048
    ds_write_b32 v2, v189 offset:2304
    ds_write_b32 v2, v190 offset:2560
    ds_write_b32 v2, v191 offset:2816
    s_mov_b32 exec_hi, 0
    ds_write_b32 v2, v192 offset:4096
    ds_write_b32 v2, v193 offset:4352
    s_mov_b64 exec, -1
P2_DW2_0:
P2_EA_W:
    v_lshlrev_b32 v64, 4, v1
    v_add_u32 v64, 54272, v64
    ds_read_b128 v[200:203], v64 offset:4096
    ds_read_b128 v[204:207], v64 offset:5120
    ds_read_b128 v[208:211], v64 offset:6144
    ds_read_b128 v[212:215], v64 offset:7168
    ds_read_b128 v[216:219], v64 offset:8192
    ds_read_b128 v[220:223], v64 offset:9216
    ds_read_b128 v[224:227], v64 offset:10240
    ds_read_b128 v[228:231], v64 offset:11264
    ds_read_b128 v[232:235], v64 offset:12288
    ds_read_b128 v[236:239], v64 offset:13312
    ds_read_b128 v[240:243], v64 offset:14336
    ds_read_b128 v[244:247], v64 offset:15360
    ds_read_b128 v[248:251], v64 offset:16384
    ds_read_b128 v[252:255], v64 offset:17408
    s_waitcnt lgkmcnt(0)
    s_barrier
    ds_read_b32 v65, v41 offset:256
    s_cmp_gt_u32 s21, 1
    s_cselect_b32 s58, s18, 0
    v_add_u32 v61, v61, v182
    buffer_load_dwordx4 v[44:47], v61, s[56:59], 0 offen sc1
    s_cmp_gt_u32 s21, 1
    s_cselect_b32 s38, s19, 0
    s_add_u32 m0, s20, 4096
    v_or_b32 v168, v168, v180
    buffer_load_dwordx4 v168, s[36:39], 0 offen  lds
    s_add_u32 m0, s20, 5120
    v_or_b32 v169, v169, v10
    buffer_load_dwordx4 v169, s[36:39], 0 offen  lds
    s_add_u32 m0, s20, 6144
    v_or_b32 v170, v170, v11
    buffer_load_dwordx4 v170, s[36:39], 0 offen  lds
    s_add_u32 m0, s20, 7168
    v_or_b32 v171, v171, v12
    buffer_load_dwordx4 v171, s[36:39], 0 offen  lds
    s_waitcnt lgkmcnt(0)
    v_readfirstlane_b32 s15, v65
    s_lshr_b32 s15, s15, 1
    s_bitcmp1_b32 s3, 1
    s_cbranch_scc1 P2_EA3
    s_cmp_lg_u32 s15, 0
    s_cbranch_scc1 P2_EA2_W
    v_exp_f32 v184, v184
    v_exp_f32 v185, v185
    v_exp_f32 v186, v186
    v_exp_f32 v187, v187
    v_exp_f32 v188, v188
    v_exp_f32 v189, v189
    v_exp_f32 v190, v190
    v_exp_f32 v191, v191
    v_exp_f32 v192, v192
    v_exp_f32 v193, v193
    v_exp_f32 v194, v194
    v_exp_f32 v195, v195
    v_exp_f32 v196, v196
    v_exp_f32 v197, v197
    v_exp_f32 v198, v198
    v_exp_f32 v199, v199
    s_nop 0
P2_EA2_W:
    s_cmp_ge_u32 s3, 4
    s_cbranch_scc1 P2_DW1_41472
    ds_write_b32 v2, v184 offset:41472
    ds_write_b32 v2, v185 offset:41728
    ds_write_b32 v2, v186 offset:41984
    ds_write_b32 v2, v187 offset:42240
    ds_write_b32 v2, v188 offset:43520
    ds_write_b32 v2, v189 offset:43776
    ds_write_b32 v2, v190 offset:44032
    ds_write_b32 v2, v191 offset:44288
    ds_write_b32 v2, v192 offset:45568
    ds_write_b32 v2, v193 offset:45824
    ds_write_b32 v2, v194 offset:46080
    ds_write_b32 v2, v195 offset:46336
    ds_write_b32 v2, v196 offset:47616
    ds_write_b32 v2, v197 offset:47872
    ds_write_b32 v2, v198 offset:48128
    ds_write_b32 v2, v199 offset:48384
    s_branch P2_DW2_41472
P2_DW1_41472:
    ds_write_b32 v2, v184 offset:41472
    ds_write_b32 v2, v185 offset:41728
    ds_write_b32 v2, v186 offset:41984
    ds_write_b32 v2, v187 offset:42240
    ds_write_b32 v2, v188 offset:43520
    ds_write_b32 v2, v189 offset:43776
    ds_write_b32 v2, v190 offset:44032
    ds_write_b32 v2, v191 offset:44288
    s_mov_b32 exec_hi, 0
    ds_write_b32 v2, v192 offset:45568
    ds_write_b32 v2, v193 offset:45824
    s_mov_b64 exec, -1
P2_DW2_41472:
P2_EA3:
    ds_read_b128 v[184:187], v64 offset:0
    ds_read_b128 v[188:191], v64 offset:1024
    ds_read_b128 v[192:195], v64 offset:2048
    ds_read_b128 v[196:199], v64 offset:3072
    s_cmp_eq_u32 s15, 0
    s_cbranch_scc1 P2_EA4
    s_waitcnt lgkmcnt(0)
    v_lshlrev_b32 v65, 4, v1
    s_mov_b32 s9, 15239168
    buffer_load_dwordx4 v[184:187], v65, s[40:43], s9 offen
    s_add_u32 s9, s9, 1024
    buffer_load_dwordx4 v[188:191], v65, s[40:43], s9 offen
    s_add_u32 s9, s9, 1024
    buffer_load_dwordx4 v[192:195], v65, s[40:43], s9 offen
    s_add_u32 s9, s9, 1024
    buffer_load_dwordx4 v[196:199], v65, s[40:43], s9 offen
    s_add_u32 s9, s9, 1024
    buffer_load_dwordx4 v[200:203], v65, s[40:43], s9 offen
    s_add_u32 s9, s9, 1024
    buffer_load_dwordx4 v[204:207], v65, s[40:43], s9 offen
    s_add_u32 s9, s9, 1024
    buffer_load_dwordx4 v[208:211], v65, s[40:43], s9 offen
    s_add_u32 s9, s9, 1024
    buffer_load_dwordx4 v[212:215], v65, s[40:43], s9 offen
    s_add_u32 s9, s9, 1024
    buffer_load_dwordx4 v[248:251], v65, s[40:43], s9 offen
    s_add_u32 s9, s9, 1024
    buffer_load_dwordx4 v[252:255], v65, s[40:43], s9 offen
    s_add_u32 s9, s9, 1024
    s_waitcnt vmcnt(0)
P2_EA4:
    s_mov_b32 s25, 1
    s_branch P2_PREP_DONE
P2_PREP_SKIP:
    s_waitcnt lgkmcnt(0)
    s_cmp_gt_u32 s21, 1
    s_cselect_b32 s58, s18, 0
    v_add_u32 v61, v61, v182
    buffer_load_dwordx4 v[44:47], v61, s[56:59], 0 offen sc1
    s_cmp_gt_u32 s21, 1
    s_cselect_b32 s38, s19, 0
    s_add_u32 m0, s20, 4096
    v_or_b32 v168, v168, v180
    buffer_load_dwordx4 v168, s[36:39], 0 offen  lds
    s_add_u32 m0, s20, 5120
    v_or_b32 v169, v169, v10
    buffer_load_dwordx4 v169, s[36:39], 0 offen  lds
    s_add_u32 m0, s20, 6144
    v_or_b32 v170, v170, v11
    buffer_load_dwordx4 v170, s[36:39], 0 offen  lds
    s_add_u32 m0, s20, 7168
    v_or_b32 v171, v171, v12
    buffer_load_dwordx4 v171, s[36:39], 0 offen  lds
P2_PREP_DONE:
    s_waitcnt lgkmcnt(0)
    s_barrier
    s_cmp_eq_u32 s21, 0
    s_cbranch_scc1 P2_MAIN_DONE
    ds_read_b128 v[152:155], v179 offset:33280
    ds_read_b32 v5, v178 offset:17024
    ds_read_b32 v6, v178 offset:17088
    ds_read_b32 v13, v178 offset:17152
    ds_read_b32 v2, v178 offset:17216
    v_mov_b32 v171, 0
    v_mov_b32 v55, 0
    s_waitcnt vmcnt(5)
    ds_read_b128 v[128:131], v172
    ds_read_b128 v[132:135], v173
    ds_read_b128 v[136:139], v174
    ds_read_b128 v[140:143], v175
    s_waitcnt lgkmcnt(4)
    v_add_u32 v60, v152, v181
    v_add_u32 v148, v152, v183
    ds_read_b64 v[156:157], v60 offset:41472
    v_add_u32 v61, v153, v181
    v_add_u32 v149, v153, v183
    ds_read_b64 v[158:159], v61 offset:41472
    v_add_u32 v62, v154, v181
    v_add_u32 v150, v154, v183
    ds_read_b64 v[160:161], v62 offset:41472
    v_add_u32 v63, v155, v181
    v_add_u32 v151, v155, v183
    ds_read_b64 v[162:163], v63 offset:41472
    v_add_u32 v5, v5, v182
    v_add_u32 v6, v6, v182
    v_add_u32 v13, v13, v182
    v_add_u32 v2, v2, v182
    s_waitcnt lgkmcnt(4)
    v_mfma_f32_32x32x16_bf16 v[64:79], v[144:147], v[248:251], 0
    v_mfma_f32_32x32x16_bf16 v[64:79], v[128:131], v[184:187], v[64:79]
    v_mfma_f32_32x32x16_bf16 v[64:79], v[132:135], v[188:191], v[64:79]
    v_mfma_f32_32x32x16_bf16 v[64:79], v[136:139], v[192:195], v[64:79]
    v_mfma_f32_32x32x16_bf16 v[64:79], v[140:143], v[196:199], v[64:79]
    v_mfma_f32_32x32x16_bf16 v[80:95], v[128:131], v[216:219], 0
    v_mfma_f32_32x32x16_bf16 v[80:95], v[132:135], v[220:223], v[80:95]
    v_mfma_f32_32x32x16_bf16 v[80:95], v[136:139], v[224:227], v[80:95]
    v_mfma_f32_32x32x16_bf16 v[80:95], v[140:143], v[228:231], v[80:95]
    s_cmp_gt_u32 s21, 2
    s_cselect_b32 s38, s19, 0
    s_add_u32 m0, s20, 0
    v_or_b32 v164, v164, v180
    buffer_load_dwordx4 v164, s[36:39], 0 offen  lds
    s_add_u32 m0, s20, 1024
    v_or_b32 v165, v165, v10
    buffer_load_dwordx4 v165, s[36:39], 0 offen  lds
    s_add_u32 m0, s20, 2048
    v_or_b32 v166, v166, v11
    buffer_load_dwordx4 v166, s[36:39], 0 offen  lds
    s_add_u32 m0, s20, 3072
    v_or_b32 v167, v167, v12
    buffer_load_dwordx4 v167, s[36:39], 0 offen  lds
    s_waitcnt lgkmcnt(0)
    s_nop 3
    s_cmp_lg_u32 s15, 0
    s_cbranch_scc1 P2_SAFE
    s_setprio 1
    v_exp_f32 v64, v64
    v_mfma_f32_32x32x16_bf16 v[96:111], v[144:147], v[252:255], 0
    v_exp_f32 v65, v65
    s_cmp_gt_u32 s21, 2
    s_cselect_b32 s58, s18, 0
    buffer_load_dwordx4 v[24:27], v5, s[56:59], 0 offen sc1
    ds_write_b32 v148, v52 offset:54276
    ds_write_b32 v149, v53 offset:54276
    ds_write_b32 v150, v54 offset:54276
    ds_write_b32 v151, v55 offset:54276
    ds_read_b128 v[48:51], v179 offset:37376
    v_exp_f32 v66, v66
    v_exp_f32 v67, v67
    v_mfma_f32_32x32x16_bf16 v[96:111], v[128:131], v[200:203], v[96:111]
    v_exp_f32 v68, v68
    v_exp_f32 v69, v69
    v_exp_f32 v70, v70
    v_mfma_f32_32x32x16_bf16 v[96:111], v[132:135], v[204:207], v[96:111]
    v_exp_f32 v71, v71
    v_exp_f32 v72, v72
    v_exp_f32 v73, v73
    v_mfma_f32_32x32x16_bf16 v[96:111], v[136:139], v[208:211], v[96:111]
    v_exp_f32 v74, v74
    v_exp_f32 v75, v75
    v_exp_f32 v76, v76
    v_mfma_f32_32x32x16_bf16 v[96:111], v[140:143], v[212:215], v[96:111]
    v_exp_f32 v77, v77
    v_exp_f32 v78, v78
    v_exp_f32 v79, v79
    s_setprio 0
    v_add_u32 v148, v152, v183
    v_add_u32 v149, v153, v183
    v_add_u32 v150, v154, v183
    v_add_u32 v151, v155, v183
    s_waitcnt lgkmcnt(5)
    v_fma_f32 v64, v64, v156, 1.0
    v_fma_f32 v65, v65, v156, 1.0
    v_fma_f32 v66, v66, v156, 1.0
    v_fma_f32 v67, v67, v156, 1.0
    v_fma_f32 v68, v68, v158, 1.0
    v_fma_f32 v69, v69, v158, 1.0
    v_fma_f32 v70, v70, v158, 1.0
    v_fma_f32 v71, v71, v158, 1.0
    v_fma_f32 v72, v72, v160, 1.0
    v_fma_f32 v73, v73, v160, 1.0
    v_fma_f32 v74, v74, v160, 1.0
    v_fma_f32 v75, v75, v160, 1.0
    v_fma_f32 v76, v76, v162, 1.0
    v_fma_f32 v77, v77, v162, 1.0
    v_fma_f32 v78, v78, v162, 1.0
    v_fma_f32 v79, v79, v162, 1.0
    s_setprio 1
    v_rcp_f32 v64, v64
    v_mfma_f32_32x32x16_bf16 v[112:127], v[128:131], v[232:235], 0
    v_rcp_f32 v65, v65
    s_waitcnt vmcnt(5)
    ds_read_b128 v[28:31], v172 offset:4096
    ds_read_b128 v[32:35], v173 offset:4096
    ds_read_b128 v[36:39], v174 offset:4096
    ds_read_b128 v[40:43], v175 offset:4096
    ds_read_b128 v[164:167], v177 offset:704
    ds_read_b128 v[152:155], v179 offset:33296
    ds_read_b32 v176, v178 offset:17152
    s_cmp_gt_u32 s21, 3
    s_cselect_b32 s38, s19, 0
    s_add_u32 m0, s20, 4096
    v_rcp_f32 v66, v66
    v_rcp_f32 v67, v67
    v_mfma_f32_32x32x16_bf16 v[112:127], v[132:135], v[236:239], v[112:127]
    v_rcp_f32 v68, v68
    v_rcp_f32 v69, v69
    v_rcp_f32 v70, v70
    v_mfma_f32_32x32x16_bf16 v[112:127], v[136:139], v[240:243], v[112:127]
    v_rcp_f32 v71, v71
    v_rcp_f32 v72, v72
    v_rcp_f32 v73, v73
    v_mfma_f32_32x32x16_bf16 v[112:127], v[140:143], v[244:247], v[112:127]
    v_rcp_f32 v74, v74
    v_rcp_f32 v75, v75
    v_rcp_f32 v76, v76
    v_rcp_f32 v77, v77
    v_rcp_f32 v78, v78
    v_rcp_f32 v79, v79
    s_setprio 0
    s_waitcnt lgkmcnt(7)
    v_and_b32 v168, v171, v48
    v_fmac_f32 v168, v64, v80
    v_fmac_f32 v168, v65, v81
    v_fmac_f32 v168, v66, v82
    v_fmac_f32 v168, v67, v83
    v_and_b32 v169, v168, v49
    v_fmac_f32 v169, v68, v84
    v_fmac_f32 v169, v69, v85
    v_fmac_f32 v169, v70, v86
    v_fmac_f32 v169, v71, v87
    v_and_b32 v170, v169, v50
    v_fmac_f32 v170, v72, v88
    v_fmac_f32 v170, v73, v89
    v_fmac_f32 v170, v74, v90
    v_fmac_f32 v170, v75, v91
    v_and_b32 v171, v170, v51
    v_fmac_f32 v171, v76, v92
    v_fmac_f32 v171, v77, v93
    v_fmac_f32 v171, v78, v94
    v_fmac_f32 v171, v79, v95
    s_waitcnt lgkmcnt(2)
    v_or_b32 v164, v164, v180
    v_or_b32 v165, v165, v10
    v_or_b32 v166, v166, v11
    v_or_b32 v167, v167, v12
    s_setprio 1
    v_exp_f32 v96, v96
    v_mfma_f32_32x32x16_bf16 v[64:79], v[44:47], v[248:251], 0
    v_exp_f32 v97, v97
    buffer_load_dwordx4 v164, s[36:39], 0 offen  lds
    s_add_u32 m0, s20, 5120
    ds_write_b32 v148, v168 offset:54272
    buffer_load_dwordx4 v165, s[36:39], 0 offen  lds
    s_add_u32 m0, s20, 6144
    ds_write_b32 v149, v169 offset:54272
    buffer_load_dwordx4 v166, s[36:39], 0 offen  lds
    s_add_u32 m0, s20, 7168
    ds_write_b32 v150, v170 offset:54272
    buffer_load_dwordx4 v167, s[36:39], 0 offen  lds
    ds_write_b32 v151, v171 offset:54272
    s_cmp_gt_u32 s21, 3
    s_cselect_b32 s58, s18, 0
    buffer_load_dwordx4 v[56:59], v6, s[56:59], 0 offen sc1
    v_exp_f32 v98, v98
    v_exp_f32 v99, v99
    v_mfma_f32_32x32x16_bf16 v[64:79], v[28:31], v[184:187], v[64:79]
    v_exp_f32 v100, v100
    v_exp_f32 v101, v101
    v_exp_f32 v102, v102
    v_mfma_f32_32x32x16_bf16 v[64:79], v[32:35], v[188:191], v[64:79]
    v_exp_f32 v103, v103
    v_exp_f32 v104, v104
    v_exp_f32 v105, v105
    v_mfma_f32_32x32x16_bf16 v[64:79], v[36:39], v[192:195], v[64:79]
    v_exp_f32 v106, v106
    v_exp_f32 v107, v107
    v_exp_f32 v108, v108
    v_mfma_f32_32x32x16_bf16 v[64:79], v[40:43], v[196:199], v[64:79]
    v_exp_f32 v109, v109
    v_exp_f32 v110, v110
    v_exp_f32 v111, v111
    s_setprio 0
    v_fma_f32 v96, v96, v157, 1.0
    v_fma_f32 v97, v97, v157, 1.0
    v_fma_f32 v98, v98, v157, 1.0
    v_fma_f32 v99, v99, v157, 1.0
    v_fma_f32 v100, v100, v159, 1.0
    v_fma_f32 v101, v101, v159, 1.0
    v_fma_f32 v102, v102, v159, 1.0
    v_fma_f32 v103, v103, v159, 1.0
    v_fma_f32 v104, v104, v161, 1.0
    v_fma_f32 v105, v105, v161, 1.0
    v_fma_f32 v106, v106, v161, 1.0
    v_fma_f32 v107, v107, v161, 1.0
    v_fma_f32 v108, v108, v163, 1.0
    v_fma_f32 v109, v109, v163, 1.0
    v_fma_f32 v110, v110, v163, 1.0
    v_fma_f32 v111, v111, v163, 1.0
    s_waitcnt lgkmcnt(4)
    v_add_u32 v60, v152, v181
    v_add_u32 v61, v153, v181
    v_add_u32 v62, v154, v181
    v_add_u32 v63, v155, v181
    v_add_u32 v176, v176, v182
    s_setprio 1
    v_rcp_f32 v96, v96
    v_mfma_f32_32x32x16_bf16 v[80:95], v[28:31], v[216:219], 0
    v_rcp_f32 v97, v97
    ds_read_b64 v[156:157], v60 offset:41472
    ds_read_b64 v[158:159], v61 offset:41472
    ds_read_b64 v[160:161], v62 offset:41472
    ds_read_b64 v[162:163], v63 offset:41472
    v_rcp_f32 v98, v98
    v_rcp_f32 v99, v99
    v_mfma_f32_32x32x16_bf16 v[80:95], v[32:35], v[220:223], v[80:95]
    v_rcp_f32 v100, v100
    v_rcp_f32 v101, v101
    v_rcp_f32 v102, v102
    v_mfma_f32_32x32x16_bf16 v[80:95], v[36:39], v[224:227], v[80:95]
    v_rcp_f32 v103, v103
    v_rcp_f32 v104, v104
    v_rcp_f32 v105, v105
    v_mfma_f32_32x32x16_bf16 v[80:95], v[40:43], v[228:231], v[80:95]
    v_rcp_f32 v106, v106
    v_rcp_f32 v107, v107
    v_rcp_f32 v108, v108
    v_rcp_f32 v109, v109
    v_rcp_f32 v110, v110
    v_rcp_f32 v111, v111
    s_setprio 0
    v_and_b32 v52, v55, v48
    v_fmac_f32 v52, v96, v112
    v_fmac_f32 v52, v97, v113
    v_fmac_f32 v52, v98, v114
    v_fmac_f32 v52, v99, v115
    v_and_b32 v53, v52, v49
    v_fmac_f32 v53, v100, v116
    v_fmac_f32 v53, v101, v117
    v_fmac_f32 v53, v102, v118
    v_fmac_f32 v53, v103, v119
    v_and_b32 v54, v53, v50
    v_fmac_f32 v54, v104, v120
    v_fmac_f32 v54, v105, v121
    v_fmac_f32 v54, v106, v122
    v_fmac_f32 v54, v107, v123
    v_and_b32 v55, v54, v51
    v_fmac_f32 v55, v108, v124
    v_fmac_f32 v55, v109, v125
    v_fmac_f32 v55, v110, v126
    v_fmac_f32 v55, v111, v127
    s_sub_u32 s21, s21, 1
    s_cmp_eq_u32 s21, 0
    s_cbranch_scc1 P2_FLUSH
    s_setprio 1
    v_exp_f32 v64, v64
    v_mfma_f32_32x32x16_bf16 v[96:111], v[44:47], v[252:255], 0
    v_exp_f32 v65, v65
    s_cmp_gt_u32 s21, 3
    s_cselect_b32 s58, s18, 0
    buffer_load_dwordx4 v[144:147], v176, s[56:59], 0 offen sc1
    ds_write_b32 v148, v52 offset:54276
    ds_write_b32 v149, v53 offset:54276
    ds_write_b32 v150, v54 offset:54276
    ds_write_b32 v151, v55 offset:54276
    ds_read_b128 v[48:51], v179 offset:37392
    v_exp_f32 v66, v66
    v_exp_f32 v67, v67
    v_mfma_f32_32x32x16_bf16 v[96:111], v[28:31], v[200:203], v[96:111]
    v_exp_f32 v68, v68
    v_exp_f32 v69, v69
    v_exp_f32 v70, v70
    v_mfma_f32_32x32x16_bf16 v[96:111], v[32:35], v[204:207], v[96:111]
    v_exp_f32 v71, v71
    v_exp_f32 v72, v72
    v_exp_f32 v73, v73
    v_mfma_f32_32x32x16_bf16 v[96:111], v[36:39], v[208:211], v[96:111]
    v_exp_f32 v74, v74
    v_exp_f32 v75, v75
    v_exp_f32 v76, v76
    v_mfma_f32_32x32x16_bf16 v[96:111], v[40:43], v[212:215], v[96:111]
    v_exp_f32 v77, v77
    v_exp_f32 v78, v78
    v_exp_f32 v79, v79
    s_setprio 0
    v_add_u32 v148, v152, v183
    v_add_u32 v149, v153, v183
    v_add_u32 v150, v154, v183
    v_add_u32 v151, v155, v183
    s_waitcnt lgkmcnt(5)
    v_fma_f32 v64, v64, v156, 1.0
    v_fma_f32 v65, v65, v156, 1.0
    v_fma_f32 v66, v66, v156, 1.0
    v_fma_f32 v67, v67, v156, 1.0
    v_fma_f32 v68, v68, v158, 1.0
    v_fma_f32 v69, v69, v158, 1.0
    v_fma_f32 v70, v70, v158, 1.0
    v_fma_f32 v71, v71, v158, 1.0
    v_fma_f32 v72, v72, v160, 1.0
    v_fma_f32 v73, v73, v160, 1.0
    v_fma_f32 v74, v74, v160, 1.0
    v_fma_f32 v75, v75, v160, 1.0
    v_fma_f32 v76, v76, v162, 1.0
    v_fma_f32 v77, v77, v162, 1.0
    v_fma_f32 v78, v78, v162, 1.0
    v_fma_f32 v79, v79, v162, 1.0
    s_setprio 1
    v_rcp_f32 v64, v64
    v_mfma_f32_32x32x16_bf16 v[112:127], v[28:31], v[232:235], 0
    v_rcp_f32 v65, v65
    s_waitcnt vmcnt(6)
    ds_read_b128 v[128:131], v172 offset:0
    ds_read_b128 v[132:135], v173 offset:0
    ds_read_b128 v[136:139], v174 offset:0
    ds_read_b128 v[140:143], v175 offset:0
    ds_read_b128 v[164:167], v177 offset:768
    ds_read_b128 v[152:155], v179 offset:33312
    ds_read_b32 v176, v178 offset:17216
    s_cmp_gt_u32 s21, 3
    s_cselect_b32 s38, s19, 0
    s_add_u32 m0, s20, 0
    v_rcp_f32 v66, v66
    v_rcp_f32 v67, v67
    v_mfma_f32_32x32x16_bf16 v[112:127], v[32:35], v[236:239], v[112:127]
    v_rcp_f32 v68, v68
    v_rcp_f32 v69, v69
    v_rcp_f32 v70, v70
    v_mfma_f32_32x32x16_bf16 v[112:127], v[36:39], v[240:243], v[112:127]
    v_rcp_f32 v71, v71
    v_rcp_f32 v72, v72
    v_rcp_f32 v73, v73
    v_mfma_f32_32x32x16_bf16 v[112:127], v[40:43], v[244:247], v[112:127]
    v_rcp_f32 v74, v74
    v_rcp_f32 v75, v75
    v_rcp_f32 v76, v76
    v_rcp_f32 v77, v77
    v_rcp_f32 v78, v78
    v_rcp_f32 v79, v79
    s_setprio 0
    s_waitcnt lgkmcnt(7)
    v_and_b32 v168, v171, v48
    v_fmac_f32 v168, v64, v80
    v_fmac_f32 v168, v65, v81
    v_fmac_f32 v168, v66, v82
    v_fmac_f32 v168, v67, v83
    v_and_b32 v169, v168, v49
    v_fmac_f32 v169, v68, v84
    v_fmac_f32 v169, v69, v85
    v_fmac_f32 v169, v70, v86
    v_fmac_f32 v169, v71, v87
    v_and_b32 v170, v169, v50
    v_fmac_f32 v170, v72, v88
    v_fmac_f32 v170, v73, v89
    v_fmac_f32 v170, v74, v90
    v_fmac_f32 v170, v75, v91
    v_and_b32 v171, v170, v51
    v_fmac_f32 v171, v76, v92
    v_fmac_f32 v171, v77, v93
    v_fmac_f32 v171, v78, v94
    v_fmac_f32 v171, v79, v95
    s_waitcnt lgkmcnt(2)
    v_or_b32 v164, v164, v180
    v_or_b32 v165, v165, v10
    v_or_b32 v166, v166, v11
    v_or_b32 v167, v167, v12
    s_setprio 1
    v_exp_f32 v96, v96
    v_mfma_f32_32x32x16_bf16 v[64:79], v[24:27], v[248:251], 0
    v_exp_f32 v97, v97
    buffer_load_dwordx4 v164, s[36:39], 0 offen  lds
    s_add_u32 m0, s20, 1024
    ds_write_b32 v148, v168 offset:54272
    buffer_load_dwordx4 v165, s[36:39], 0 offen  lds
    s_add_u32 m0, s20, 2048
    ds_write_b32 v149, v169 offset:54272
    buffer_load_dwordx4 v166, s[36:39], 0 offen  lds
    s_add_u32 m0, s20, 3072
    ds_write_b32 v150, v170 offset:54272
    buffer_load_dwordx4 v167, s[36:39], 0 offen  lds
    ds_write_b32 v151, v171 offset:54272
    v_exp_f32 v98, v98
    v_exp_f32 v99, v99
    v_mfma_f32_32x32x16_bf16 v[64:79], v[128:131], v[184:187], v[64:79]
    v_exp_f32 v100, v100
    v_exp_f32 v101, v101
    v_exp_f32 v102, v102
    v_mfma_f32_32x32x16_bf16 v[64:79], v[132:135], v[188:191], v[64:79]
    v_exp_f32 v103, v103
    v_exp_f32 v104, v104
    v_exp_f32 v105, v105
    v_mfma_f32_32x32x16_bf16 v[64:79], v[136:139], v[192:195], v[64:79]
    v_exp_f32 v106, v106
    v_exp_f32 v107, v107
    v_exp_f32 v108, v108
    v_mfma_f32_32x32x16_bf16 v[64:79], v[140:143], v[196:199], v[64:79]
    v_exp_f32 v109, v109
    v_exp_f32 v110, v110
    v_exp_f32 v111, v111
    s_setprio 0
    v_fma_f32 v96, v96, v157, 1.0
    v_fma_f32 v97, v97, v157, 1.0
    v_fma_f32 v98, v98, v157, 1.0
    v_fma_f32 v99, v99, v157, 1.0
    v_fma_f32 v100, v100, v159, 1.0
    v_fma_f32 v101, v101, v159, 1.0
    v_fma_f32 v102, v102, v159, 1.0
    v_fma_f32 v103, v103, v159, 1.0
    v_fma_f32 v104, v104, v161, 1.0
    v_fma_f32 v105, v105, v161, 1.0
    v_fma_f32 v106, v106, v161, 1.0
    v_fma_f32 v107, v107, v161, 1.0
    v_fma_f32 v108, v108, v163, 1.0
    v_fma_f32 v109, v109, v163, 1.0
    v_fma_f32 v110, v110, v163, 1.0
    v_fma_f32 v111, v111, v163, 1.0
    s_waitcnt lgkmcnt(4)
    v_add_u32 v60, v152, v181
    v_add_u32 v61, v153, v181
    v_add_u32 v62, v154, v181
    v_add_u32 v63, v155, v181
    v_add_u32 v176, v176, v182
    s_setprio 1
    v_rcp_f32 v96, v96
    v_mfma_f32_32x32x16_bf16 v[80:95], v[128:131], v[216:219], 0
    v_rcp_f32 v97, v97
    ds_read_b64 v[156:157], v60 offset:41472
    ds_read_b64 v[158:159], v61 offset:41472
    ds_read_b64 v[160:161], v62 offset:41472
    ds_read_b64 v[162:163], v63 offset:41472
    v_rcp_f32 v98, v98
    v_rcp_f32 v99, v99
    v_mfma_f32_32x32x16_bf16 v[80:95], v[132:135], v[220:223], v[80:95]
    v_rcp_f32 v100, v100
    v_rcp_f32 v101, v101
    v_rcp_f32 v102, v102
    v_mfma_f32_32x32x16_bf16 v[80:95], v[136:139], v[224:227], v[80:95]
    v_rcp_f32 v103, v103
    v_rcp_f32 v104, v104
    v_rcp_f32 v105, v105
    v_mfma_f32_32x32x16_bf16 v[80:95], v[140:143], v[228:231], v[80:95]
    v_rcp_f32 v106, v106
    v_rcp_f32 v107, v107
    v_rcp_f32 v108, v108
    v_rcp_f32 v109, v109
    v_rcp_f32 v110, v110
    v_rcp_f32 v111, v111
    s_setprio 0
    v_and_b32 v52, v55, v48
    v_fmac_f32 v52, v96, v112
    v_fmac_f32 v52, v97, v113
    v_fmac_f32 v52, v98, v114
    v_fmac_f32 v52, v99, v115
    v_and_b32 v53, v52, v49
    v_fmac_f32 v53, v100, v116
    v_fmac_f32 v53, v101, v117
    v_fmac_f32 v53, v102, v118
    v_fmac_f32 v53, v103, v119
    v_and_b32 v54, v53, v50
    v_fmac_f32 v54, v104, v120
    v_fmac_f32 v54, v105, v121
    v_fmac_f32 v54, v106, v122
    v_fmac_f32 v54, v107, v123
    v_and_b32 v55, v54, v51
    v_fmac_f32 v55, v108, v124
    v_fmac_f32 v55, v109, v125
    v_fmac_f32 v55, v110, v126
    v_fmac_f32 v55, v111, v127
    s_sub_u32 s21, s21, 1
    s_cmp_eq_u32 s21, 0
    s_cbranch_scc1 P2_FLUSH
    s_setprio 1
    v_exp_f32 v64, v64
    v_mfma_f32_32x32x16_bf16 v[96:111], v[24:27], v[252:255], 0
    v_exp_f32 v65, v65
    s_cmp_gt_u32 s21, 3
    s_cselect_b32 s58, s18, 0
    buffer_load_dwordx4 v[44:47], v176, s[56:59], 0 offen sc1
    ds_write_b32 v148, v52 offset:54276
    ds_write_b32 v149, v53 offset:54276
    ds_write_b32 v150, v54 offset:54276
    ds_write_b32 v151, v55 offset:54276
    ds_read_b128 v[48:51], v179 offset:37408
    v_exp_f32 v66, v66
    v_exp_f32 v67, v67
    v_mfma_f32_32x32x16_bf16 v[96:111], v[128:131], v[200:203], v[96:111]
    v_exp_f32 v68, v68
    v_exp_f32 v69, v69
    v_exp_f32 v70, v70
    v_mfma_f32_32x32x16_bf16 v[96:111], v[132:135], v[204:207], v[96:111]
    v_exp_f32 v71, v71
    v_exp_f32 v72, v72
    v_exp_f32 v73, v73
    v_mfma_f32_32x32x16_bf16 v[96:111], v[136:139], v[208:211], v[96:111]
    v_exp_f32 v74, v74
    v_exp_f32 v75, v75
    v_exp_f32 v76, v76
    v_mfma_f32_32x32x16_bf16 v[96:111], v[140:143], v[212:215], v[96:111]
    v_exp_f32 v77, v77
    v_exp_f32 v78, v78
    v_exp_f32 v79, v79
    s_setprio 0
    v_add_u32 v148, v152, v183
    v_add_u32 v149, v153, v183
    v_add_u32 v150, v154, v183
    v_add_u32 v151, v155, v183
    s_waitcnt lgkmcnt(5)
    v_fma_f32 v64, v64, v156, 1.0
    v_fma_f32 v65, v65, v156, 1.0
    v_fma_f32 v66, v66, v156, 1.0
    v_fma_f32 v67, v67, v156, 1.0
    v_fma_f32 v68, v68, v158, 1.0
    v_fma_f32 v69, v69, v158, 1.0
    v_fma_f32 v70, v70, v158, 1.0
    v_fma_f32 v71, v71, v158, 1.0
    v_fma_f32 v72, v72, v160, 1.0
    v_fma_f32 v73, v73, v160, 1.0
    v_fma_f32 v74, v74, v160, 1.0
    v_fma_f32 v75, v75, v160, 1.0
    v_fma_f32 v76, v76, v162, 1.0
    v_fma_f32 v77, v77, v162, 1.0
    v_fma_f32 v78, v78, v162, 1.0
    v_fma_f32 v79, v79, v162, 1.0
    s_setprio 1
    v_rcp_f32 v64, v64
    v_mfma_f32_32x32x16_bf16 v[112:127], v[128:131], v[232:235], 0
    v_rcp_f32 v65, v65
    s_waitcnt vmcnt(6)
    ds_read_b128 v[28:31], v172 offset:4096
    ds_read_b128 v[32:35], v173 offset:4096
    ds_read_b128 v[36:39], v174 offset:4096
    ds_read_b128 v[40:43], v175 offset:4096
    ds_read_b128 v[164:167], v177 offset:832
    ds_read_b128 v[152:155], v179 offset:33328
    ds_read_b32 v176, v178 offset:17280
    s_cmp_gt_u32 s21, 3
    s_cselect_b32 s38, s19, 0
    s_add_u32 m0, s20, 4096
    v_rcp_f32 v66, v66
    v_rcp_f32 v67, v67
    v_mfma_f32_32x32x16_bf16 v[112:127], v[132:135], v[236:239], v[112:127]
    v_rcp_f32 v68, v68
    v_rcp_f32 v69, v69
    v_rcp_f32 v70, v70
    v_mfma_f32_32x32x16_bf16 v[112:127], v[136:139], v[240:243], v[112:127]
    v_rcp_f32 v71, v71
    v_rcp_f32 v72, v72
    v_rcp_f32 v73, v73
    v_mfma_f32_32x32x16_bf16 v[112:127], v[140:143], v[244:247], v[112:127]
    v_rcp_f32 v74, v74
    v_rcp_f32 v75, v75
    v_rcp_f32 v76, v76
    v_rcp_f32 v77, v77
    v_rcp_f32 v78, v78
    v_rcp_f32 v79, v79
    s_setprio 0
    s_waitcnt lgkmcnt(7)
    v_and_b32 v168, v171, v48
    v_fmac_f32 v168, v64, v80
    v_fmac_f32 v168, v65, v81
    v_fmac_f32 v168, v66, v82
    v_fmac_f32 v168, v67, v83
    v_and_b32 v169, v168, v49
    v_fmac_f32 v169, v68, v84
    v_fmac_f32 v169, v69, v85
    v_fmac_f32 v169, v70, v86
    v_fmac_f32 v169, v71, v87
    v_and_b32 v170, v169, v50
    v_fmac_f32 v170, v72, v88
    v_fmac_f32 v170, v73, v89
    v_fmac_f32 v170, v74, v90
    v_fmac_f32 v170, v75, v91
    v_and_b32 v171, v170, v51
    v_fmac_f32 v171, v76, v92
    v_fmac_f32 v171, v77, v93
    v_fmac_f32 v171, v78, v94
    v_fmac_f32 v171, v79, v95
    s_waitcnt lgkmcnt(2)
    v_or_b32 v164, v164, v180
    v_or_b32 v165, v165, v10
    v_or_b32 v166, v166, v11
    v_or_b32 v167, v167, v12
    s_setprio 1
    v_exp_f32 v96, v96
    v_mfma_f32_32x32x16_bf16 v[64:79], v[56:59], v[248:251], 0
    v_exp_f32 v97, v97
    buffer_load_dwordx4 v164, s[36:39], 0 offen  lds
    s_add_u32 m0, s20, 5120
    ds_write_b32 v148, v168 offset:54272
    buffer_load_dwordx4 v165, s[36:39], 0 offen  lds
    s_add_u32 m0, s20, 6144
    ds_write_b32 v149, v169 offset:54272
    buffer_load_dwordx4 v166, s[36:39], 0 offen  lds
    s_add_u32 m0, s20, 7168
    ds_write_b32 v150, v170 offset:54272
    buffer_load_dwordx4 v167, s[36:39], 0 offen  lds
    ds_write_b32 v151, v171 offset:54272
    v_exp_f32 v98, v98
    v_exp_f32 v99, v99
    v_mfma_f32_32x32x16_bf16 v[64:79], v[28:31], v[184:187], v[64:79]
    v_exp_f32 v100, v100
    v_exp_f32 v101, v101
    v_exp_f32 v102, v102
    v_mfma_f32_32x32x16_bf16 v[64:79], v[32:35], v[188:191], v[64:79]
    v_exp_f32 v103, v103
    v_exp_f32 v104, v104
    v_exp_f32 v105, v105
    v_mfma_f32_32x32x16_bf16 v[64:79], v[36:39], v[192:195], v[64:79]
    v_exp_f32 v106, v106
    v_exp_f32 v107, v107
    v_exp_f32 v108, v108
    v_mfma_f32_32x32x16_bf16 v[64:79], v[40:43], v[196:199], v[64:79]
    v_exp_f32 v109, v109
    v_exp_f32 v110, v110
    v_exp_f32 v111, v111
    s_setprio 0
    v_fma_f32 v96, v96, v157, 1.0
    v_fma_f32 v97, v97, v157, 1.0
    v_fma_f32 v98, v98, v157, 1.0
    v_fma_f32 v99, v99, v157, 1.0
    v_fma_f32 v100, v100, v159, 1.0
    v_fma_f32 v101, v101, v159, 1.0
    v_fma_f32 v102, v102, v159, 1.0
    v_fma_f32 v103, v103, v159, 1.0
    v_fma_f32 v104, v104, v161, 1.0
    v_fma_f32 v105, v105, v161, 1.0
    v_fma_f32 v106, v106, v161, 1.0
    v_fma_f32 v107, v107, v161, 1.0
    v_fma_f32 v108, v108, v163, 1.0
    v_fma_f32 v109, v109, v163, 1.0
    v_fma_f32 v110, v110, v163, 1.0
    v_fma_f32 v111, v111, v163, 1.0
    s_waitcnt lgkmcnt(4)
    v_add_u32 v60, v152, v181
    v_add_u32 v61, v153, v181
    v_add_u32 v62, v154, v181
    v_add_u32 v63, v155, v181
    v_add_u32 v176, v176, v182
    s_setprio 1
    v_rcp_f32 v96, v96
    v_mfma_f32_32x32x16_bf16 v[80:95], v[28:31], v[216:219], 0
    v_rcp_f32 v97, v97
    ds_read_b64 v[156:157], v60 offset:41472
    ds_read_b64 v[158:159], v61 offset:41472
    ds_read_b64 v[160:161], v62 offset:41472
    ds_read_b64 v[162:163], v63 offset:41472
    v_rcp_f32 v98, v98
    v_rcp_f32 v99, v99
    v_mfma_f32_32x32x16_bf16 v[80:95], v[32:35], v[220:223], v[80:95]
    v_rcp_f32 v100, v100
    v_rcp_f32 v101, v101
    v_rcp_f32 v102, v102
    v_mfma_f32_32x32x16_bf16 v[80:95], v[36:39], v[224:227], v[80:95]
    v_rcp_f32 v103, v103
    v_rcp_f32 v104, v104
    v_rcp_f32 v105, v105
    v_mfma_f32_32x32x16_bf16 v[80:95], v[40:43], v[228:231], v[80:95]
    v_rcp_f32 v106, v106
    v_rcp_f32 v107, v107
    v_rcp_f32 v108, v108
    v_rcp_f32 v109, v109
    v_rcp_f32 v110, v110
    v_rcp_f32 v111, v111
    s_setprio 0
    v_and_b32 v52, v55, v48
    v_fmac_f32 v52, v96, v112
    v_fmac_f32 v52, v97, v113
    v_fmac_f32 v52, v98, v114
    v_fmac_f32 v52, v99, v115
    v_and_b32 v53, v52, v49
    v_fmac_f32 v53, v100, v116
    v_fmac_f32 v53, v101, v117
    v_fmac_f32 v53, v102, v118
    v_fmac_f32 v53, v103, v119
    v_and_b32 v54, v53, v50
    v_fmac_f32 v54, v104, v120
    v_fmac_f32 v54, v105, v121
    v_fmac_f32 v54, v106, v122
    v_fmac_f32 v54, v107, v123
    v_and_b32 v55, v54, v51
    v_fmac_f32 v55, v108, v124
    v_fmac_f32 v55, v109, v125
    v_fmac_f32 v55, v110, v126
    v_fmac_f32 v55, v111, v127
    s_sub_u32 s21, s21, 1
    s_cmp_eq_u32 s21, 0
    s_cbranch_scc1 P2_FLUSH
    s_setprio 1
    v_exp_f32 v64, v64
    v_mfma_f32_32x32x16_bf16 v[96:111], v[56:59], v[252:255], 0
    v_exp_f32 v65, v65
    s_cmp_gt_u32 s21, 3
    s_cselect_b32 s58, s18, 0
    buffer_load_dwordx4 v[24:27], v176, s[56:59], 0 offen sc1
    ds_write_b32 v148, v52 offset:54276
    ds_write_b32 v149, v53 offset:54276
    ds_write_b32 v150, v54 offset:54276
    ds_write_b32 v151, v55 offset:54276
    ds_read_b128 v[48:51], v179 offset:37424
    v_exp_f32 v66, v66
    v_exp_f32 v67, v67
    v_mfma_f32_32x32x16_bf16 v[96:111], v[28:31], v[200:203], v[96:111]
    v_exp_f32 v68, v68
    v_exp_f32 v69, v69
    v_exp_f32 v70, v70
    v_mfma_f32_32x32x16_bf16 v[96:111], v[32:35], v[204:207], v[96:111]
    v_exp_f32 v71, v71
    v_exp_f32 v72, v72
    v_exp_f32 v73, v73
    v_mfma_f32_32x32x16_bf16 v[96:111], v[36:39], v[208:211], v[96:111]
    v_exp_f32 v74, v74
    v_exp_f32 v75, v75
    v_exp_f32 v76, v76
    v_mfma_f32_32x32x16_bf16 v[96:111], v[40:43], v[212:215], v[96:111]
    v_exp_f32 v77, v77
    v_exp_f32 v78, v78
    v_exp_f32 v79, v79
    s_setprio 0
    v_add_u32 v148, v152, v183
    v_add_u32 v149, v153, v183
    v_add_u32 v150, v154, v183
    v_add_u32 v151, v155, v183
    s_waitcnt lgkmcnt(5)
    v_fma_f32 v64, v64, v156, 1.0
    v_fma_f32 v65, v65, v156, 1.0
    v_fma_f32 v66, v66, v156, 1.0
    v_fma_f32 v67, v67, v156, 1.0
    v_fma_f32 v68, v68, v158, 1.0
    v_fma_f32 v69, v69, v158, 1.0
    v_fma_f32 v70, v70, v158, 1.0
    v_fma_f32 v71, v71, v158, 1.0
    v_fma_f32 v72, v72, v160, 1.0
    v_fma_f32 v73, v73, v160, 1.0
    v_fma_f32 v74, v74, v160, 1.0
    v_fma_f32 v75, v75, v160, 1.0
    v_fma_f32 v76, v76, v162, 1.0
    v_fma_f32 v77, v77, v162, 1.0
    v_fma_f32 v78, v78, v162, 1.0
    v_fma_f32 v79, v79, v162, 1.0
    s_setprio 1
    v_rcp_f32 v64, v64
    v_mfma_f32_32x32x16_bf16 v[112:127], v[28:31], v[232:235], 0
    v_rcp_f32 v65, v65
    s_waitcnt vmcnt(6)
    ds_read_b128 v[128:131], v172 offset:0
    ds_read_b128 v[132:135], v173 offset:0
    ds_read_b128 v[136:139], v174 offset:0
    ds_read_b128 v[140:143], v175 offset:0
    ds_read_b128 v[164:167], v177 offset:896
    ds_read_b128 v[152:155], v179 offset:33344
    ds_read_b32 v176, v178 offset:17344
    s_cmp_gt_u32 s21, 3
    s_cselect_b32 s38, s19, 0
    s_add_u32 m0, s20, 0
    v_rcp_f32 v66, v66
    v_rcp_f32 v67, v67
    v_mfma_f32_32x32x16_bf16 v[112:127], v[32:35], v[236:239], v[112:127]
    v_rcp_f32 v68, v68
    v_rcp_f32 v69, v69
    v_rcp_f32 v70, v70
    v_mfma_f32_32x32x16_bf16 v[112:127], v[36:39], v[240:243], v[112:127]
    v_rcp_f32 v71, v71
    v_rcp_f32 v72, v72
    v_rcp_f32 v73, v73
    v_mfma_f32_32x32x16_bf16 v[112:127], v[40:43], v[244:247], v[112:127]
    v_rcp_f32 v74, v74
    v_rcp_f32 v75, v75
    v_rcp_f32 v76, v76
    v_rcp_f32 v77, v77
    v_rcp_f32 v78, v78
    v_rcp_f32 v79, v79
    s_setprio 0
    s_waitcnt lgkmcnt(7)
    v_and_b32 v168, v171, v48
    v_fmac_f32 v168, v64, v80
    v_fmac_f32 v168, v65, v81
    v_fmac_f32 v168, v66, v82
    v_fmac_f32 v168, v67, v83
    v_and_b32 v169, v168, v49
    v_fmac_f32 v169, v68, v84
    v_fmac_f32 v169, v69, v85
    v_fmac_f32 v169, v70, v86
    v_fmac_f32 v169, v71, v87
    v_and_b32 v170, v169, v50
    v_fmac_f32 v170, v72, v88
    v_fmac_f32 v170, v73, v89
    v_fmac_f32 v170, v74, v90
    v_fmac_f32 v170, v75, v91
    v_and_b32 v171, v170, v51
    v_fmac_f32 v171, v76, v92
    v_fmac_f32 v171, v77, v93
    v_fmac_f32 v171, v78, v94
    v_fmac_f32 v171, v79, v95
    s_waitcnt lgkmcnt(2)
    v_or_b32 v164, v164, v180
    v_or_b32 v165, v165, v10
    v_or_b32 v166, v166, v11
    v_or_b32 v167, v167, v12
    s_setprio 1
    v_exp_f32 v96, v96
    v_mfma_f32_32x32x16_bf16 v[64:79], v[144:147], v[248:251], 0
    v_exp_f32 v97, v97
    buffer_load_dwordx4 v164, s[36:39], 0 offen  lds
    s_add_u32 m0, s20, 1024
    ds_write_b32 v148, v168 offset:54272
    buffer_load_dwordx4 v165, s[36:39], 0 offen  lds
    s_add_u32 m0, s20, 2048
    ds_write_b32 v149, v169 offset:54272
    buffer_load_dwordx4 v166, s[36:39], 0 offen  lds
    s_add_u32 m0, s20, 3072
    ds_write_b32 v150, v170 offset:54272
    buffer_load_dwordx4 v167, s[36:39], 0 offen  lds
    ds_write_b32 v151, v171 offset:54272
    v_exp_f32 v98, v98
    v_exp_f32 v99, v99
    v_mfma_f32_32x32x16_bf16 v[64:79], v[128:131], v[184:187], v[64:79]
    v_exp_f32 v100, v100
    v_exp_f32 v101, v101
    v_exp_f32 v102, v102
    v_mfma_f32_32x32x16_bf16 v[64:79], v[132:135], v[188:191], v[64:79]
    v_exp_f32 v103, v103
    v_exp_f32 v104, v104
    v_exp_f32 v105, v105
    v_mfma_f32_32x32x16_bf16 v[64:79], v[136:139], v[192:195], v[64:79]
    v_exp_f32 v106, v106
    v_exp_f32 v107, v107
    v_exp_f32 v108, v108
    v_mfma_f32_32x32x16_bf16 v[64:79], v[140:143], v[196:199], v[64:79]
    v_exp_f32 v109, v109
    v_exp_f32 v110, v110
    v_exp_f32 v111, v111
    s_setprio 0
    v_fma_f32 v96, v96, v157, 1.0
    v_fma_f32 v97, v97, v157, 1.0
    v_fma_f32 v98, v98, v157, 1.0
    v_fma_f32 v99, v99, v157, 1.0
    v_fma_f32 v100, v100, v159, 1.0
    v_fma_f32 v101, v101, v159, 1.0
    v_fma_f32 v102, v102, v159, 1.0
    v_fma_f32 v103, v103, v159, 1.0
    v_fma_f32 v104, v104, v161, 1.0
    v_fma_f32 v105, v105, v161, 1.0
    v_fma_f32 v106, v106, v161, 1.0
    v_fma_f32 v107, v107, v161, 1.0
    v_fma_f32 v108, v108, v163, 1.0
    v_fma_f32 v109, v109, v163, 1.0
    v_fma_f32 v110, v110, v163, 1.0
    v_fma_f32 v111, v111, v163, 1.0
    s_waitcnt lgkmcnt(4)
    v_add_u32 v60, v152, v181
    v_add_u32 v61, v153, v181
    v_add_u32 v62, v154, v181
    v_add_u32 v63, v155, v181
    v_add_u32 v176, v176, v182
    s_setprio 1
    v_rcp_f32 v96, v96
    v_mfma_f32_32x32x16_bf16 v[80:95], v[128:131], v[216:219], 0
    v_rcp_f32 v97, v97
    ds_read_b64 v[156:157], v60 offset:41472
    ds_read_b64 v[158:159], v61 offset:41472
    ds_read_b64 v[160:161], v62 offset:41472
    ds_read_b64 v[162:163], v63 offset:41472
    v_rcp_f32 v98, v98
    v_rcp_f32 v99, v99
    v_mfma_f32_32x32x16_bf16 v[80:95], v[132:135], v[220:223], v[80:95]
    v_rcp_f32 v100, v100
    v_rcp_f32 v101, v101
    v_rcp_f32 v102, v102
    v_mfma_f32_32x32x16_bf16 v[80:95], v[136:139], v[224:227], v[80:95]
    v_rcp_f32 v103, v103
    v_rcp_f32 v104, v104
    v_rcp_f32 v105, v105
    v_mfma_f32_32x32x16_bf16 v[80:95], v[140:143], v[228:231], v[80:95]
    v_rcp_f32 v106, v106
    v_rcp_f32 v107, v107
    v_rcp_f32 v108, v108
    v_rcp_f32 v109, v109
    v_rcp_f32 v110, v110
    v_rcp_f32 v111, v111
    s_setprio 0
    v_and_b32 v52, v55, v48
    v_fmac_f32 v52, v96, v112
    v_fmac_f32 v52, v97, v113
    v_fmac_f32 v52, v98, v114
    v_fmac_f32 v52, v99, v115
    v_and_b32 v53, v52, v49
    v_fmac_f32 v53, v100, v116
    v_fmac_f32 v53, v101, v117
    v_fmac_f32 v53, v102, v118
    v_fmac_f32 v53, v103, v119
    v_and_b32 v54, v53, v50
    v_fmac_f32 v54, v104, v120
    v_fmac_f32 v54, v105, v121
    v_fmac_f32 v54, v106, v122
    v_fmac_f32 v54, v107, v123
    v_and_b32 v55, v54, v51
    v_fmac_f32 v55, v108, v124
    v_fmac_f32 v55, v109, v125
    v_fmac_f32 v55, v110, v126
    v_fmac_f32 v55, v111, v127
    v_add_u32 v177, 256, v177
    v_add_u32 v178, 256, v178
    v_add_u32 v179, 64, v179
    s_sub_u32 s21, s21, 1
    s_cmp_lg_u32 s21, 0
    s_cbranch_scc1 P2_LOOPF
    s_branch P2_FLUSH
P2_LOOPF:
    s_setprio 1
    v_exp_f32 v64, v64
    v_mfma_f32_32x32x16_bf16 v[96:111], v[144:147], v[252:255], 0
    v_exp_f32 v65, v65
    s_cmp_gt_u32 s21, 3
    s_cselect_b32 s58, s18, 0
    buffer_load_dwordx4 v[56:59], v176, s[56:59], 0 offen sc1
    ds_write_b32 v148, v52 offset:54276
    ds_write_b32 v149, v53 offset:54276
    ds_write_b32 v150, v54 offset:54276
    ds_write_b32 v151, v55 offset:54276
    ds_read_b128 v[48:51], v179 offset:37376
    v_exp_f32 v66, v66
    v_exp_f32 v67, v67
    v_mfma_f32_32x32x16_bf16 v[96:111], v[128:131], v[200:203], v[96:111]
    v_exp_f32 v68, v68
    v_exp_f32 v69, v69
    v_exp_f32 v70, v70
    v_mfma_f32_32x32x16_bf16 v[96:111], v[132:135], v[204:207], v[96:111]
    v_exp_f32 v71, v71
    v_exp_f32 v72, v72
    v_exp_f32 v73, v73
    v_mfma_f32_32x32x16_bf16 v[96:111], v[136:139], v[208:211], v[96:111]
    v_exp_f32 v74, v74
    v_exp_f32 v75, v75
    v_exp_f32 v76, v76
    v_mfma_f32_32x32x16_bf16 v[96:111], v[140:143], v[212:215], v[96:111]
    v_exp_f32 v77, v77
    v_exp_f32 v78, v78
    v_exp_f32 v79, v79
    s_setprio 0
    v_add_u32 v148, v152, v183
    v_add_u32 v149, v153, v183
    v_add_u32 v150, v154, v183
    v_add_u32 v151, v155, v183
    s_waitcnt lgkmcnt(5)
    v_fma_f32 v64, v64, v156, 1.0
    v_fma_f32 v65, v65, v156, 1.0
    v_fma_f32 v66, v66, v156, 1.0
    v_fma_f32 v67, v67, v156, 1.0
    v_fma_f32 v68, v68, v158, 1.0
    v_fma_f32 v69, v69, v158, 1.0
    v_fma_f32 v70, v70, v158, 1.0
    v_fma_f32 v71, v71, v158, 1.0
    v_fma_f32 v72, v72, v160, 1.0
    v_fma_f32 v73, v73, v160, 1.0
    v_fma_f32 v74, v74, v160, 1.0
    v_fma_f32 v75, v75, v160, 1.0
    v_fma_f32 v76, v76, v162, 1.0
    v_fma_f32 v77, v77, v162, 1.0
    v_fma_f32 v78, v78, v162, 1.0
    v_fma_f32 v79, v79, v162, 1.0
    s_setprio 1
    v_rcp_f32 v64, v64
    v_mfma_f32_32x32x16_bf16 v[112:127], v[128:131], v[232:235], 0
    v_rcp_f32 v65, v65
    s_waitcnt vmcnt(6)
    ds_read_b128 v[28:31], v172 offset:4096
    ds_read_b128 v[32:35], v173 offset:4096
    ds_read_b128 v[36:39], v174 offset:4096
    ds_read_b128 v[40:43], v175 offset:4096
    ds_read_b128 v[164:167], v177 offset:704
    ds_read_b128 v[152:155], v179 offset:33296
    ds_read_b32 v176, v178 offset:17152
    s_cmp_gt_u32 s21, 3
    s_cselect_b32 s38, s19, 0
    s_add_u32 m0, s20, 4096
    v_rcp_f32 v66, v66
    v_rcp_f32 v67, v67
    v_mfma_f32_32x32x16_bf16 v[112:127], v[132:135], v[236:239], v[112:127]
    v_rcp_f32 v68, v68
    v_rcp_f32 v69, v69
    v_rcp_f32 v70, v70
    v_mfma_f32_32x32x16_bf16 v[112:127], v[136:139], v[240:243], v[112:127]
    v_rcp_f32 v71, v71
    v_rcp_f32 v72, v72
    v_rcp_f32 v73, v73
    v_mfma_f32_32x32x16_bf16 v[112:127], v[140:143], v[244:247], v[112:127]
    v_rcp_f32 v74, v74
    v_rcp_f32 v75, v75
    v_rcp_f32 v76, v76
    v_rcp_f32 v77, v77
    v_rcp_f32 v78, v78
    v_rcp_f32 v79, v79
    s_setprio 0
    s_waitcnt lgkmcnt(7)
    v_and_b32 v168, v171, v48
    v_fmac_f32 v168, v64, v80
    v_fmac_f32 v168, v65, v81
    v_fmac_f32 v168, v66, v82
    v_fmac_f32 v168, v67, v83
    v_and_b32 v169, v168, v49
    v_fmac_f32 v169, v68, v84
    v_fmac_f32 v169, v69, v85
    v_fmac_f32 v169, v70, v86
    v_fmac_f32 v169, v71, v87
    v_and_b32 v170, v169, v50
    v_fmac_f32 v170, v72, v88
    v_fmac_f32 v170, v73, v89
    v_fmac_f32 v170, v74, v90
    v_fmac_f32 v170, v75, v91
    v_and_b32 v171, v170, v51
    v_fmac_f32 v171, v76, v92
    v_fmac_f32 v171, v77, v93
    v_fmac_f32 v171, v78, v94
    v_fmac_f32 v171, v79, v95
    s_waitcnt lgkmcnt(2)
    v_or_b32 v164, v164, v180
    v_or_b32 v165, v165, v10
    v_or_b32 v166, v166, v11
    v_or_b32 v167, v167, v12
    s_setprio 1
    v_exp_f32 v96, v96
    v_mfma_f32_32x32x16_bf16 v[64:79], v[44:47], v[248:251], 0
    v_exp_f32 v97, v97
    buffer_load_dwordx4 v164, s[36:39], 0 offen  lds
    s_add_u32 m0, s20, 5120
    ds_write_b32 v148, v168 offset:54272
    buffer_load_dwordx4 v165, s[36:39], 0 offen  lds
    s_add_u32 m0, s20, 6144
    ds_write_b32 v149, v169 offset:54272
    buffer_load_dwordx4 v166, s[36:39], 0 offen  lds
    s_add_u32 m0, s20, 7168
    ds_write_b32 v150, v170 offset:54272
    buffer_load_dwordx4 v167, s[36:39], 0 offen  lds
    ds_write_b32 v151, v171 offset:54272
    v_exp_f32 v98, v98
    v_exp_f32 v99, v99
    v_mfma_f32_32x32x16_bf16 v[64:79], v[28:31], v[184:187], v[64:79]
    v_exp_f32 v100, v100
    v_exp_f32 v101, v101
    v_exp_f32 v102, v102
    v_mfma_f32_32x32x16_bf16 v[64:79], v[32:35], v[188:191], v[64:79]
    v_exp_f32 v103, v103
    v_exp_f32 v104, v104
    v_exp_f32 v105, v105
    v_mfma_f32_32x32x16_bf16 v[64:79], v[36:39], v[192:195], v[64:79]
    v_exp_f32 v106, v106
    v_exp_f32 v107, v107
    v_exp_f32 v108, v108
    v_mfma_f32_32x32x16_bf16 v[64:79], v[40:43], v[196:199], v[64:79]
    v_exp_f32 v109, v109
    v_exp_f32 v110, v110
    v_exp_f32 v111, v111
    s_setprio 0
    v_fma_f32 v96, v96, v157, 1.0
    v_fma_f32 v97, v97, v157, 1.0
    v_fma_f32 v98, v98, v157, 1.0
    v_fma_f32 v99, v99, v157, 1.0
    v_fma_f32 v100, v100, v159, 1.0
    v_fma_f32 v101, v101, v159, 1.0
    v_fma_f32 v102, v102, v159, 1.0
    v_fma_f32 v103, v103, v159, 1.0
    v_fma_f32 v104, v104, v161, 1.0
    v_fma_f32 v105, v105, v161, 1.0
    v_fma_f32 v106, v106, v161, 1.0
    v_fma_f32 v107, v107, v161, 1.0
    v_fma_f32 v108, v108, v163, 1.0
    v_fma_f32 v109, v109, v163, 1.0
    v_fma_f32 v110, v110, v163, 1.0
    v_fma_f32 v111, v111, v163, 1.0
    s_waitcnt lgkmcnt(4)
    v_add_u32 v60, v152, v181
    v_add_u32 v61, v153, v181
    v_add_u32 v62, v154, v181
    v_add_u32 v63, v155, v181
    v_add_u32 v176, v176, v182
    s_setprio 1
    v_rcp_f32 v96, v96
    v_mfma_f32_32x32x16_bf16 v[80:95], v[28:31], v[216:219], 0
    v_rcp_f32 v97, v97
    ds_read_b64 v[156:157], v60 offset:41472
    ds_read_b64 v[158:159], v61 offset:41472
    ds_read_b64 v[160:161], v62 offset:41472
    ds_read_b64 v[162:163], v63 offset:41472
    v_rcp_f32 v98, v98
    v_rcp_f32 v99, v99
    v_mfma_f32_32x32x16_bf16 v[80:95], v[32:35], v[220:223], v[80:95]
    v_rcp_f32 v100, v100
    v_rcp_f32 v101, v101
    v_rcp_f32 v102, v102
    v_mfma_f32_32x32x16_bf16 v[80:95], v[36:39], v[224:227], v[80:95]
    v_rcp_f32 v103, v103
    v_rcp_f32 v104, v104
    v_rcp_f32 v105, v105
    v_mfma_f32_32x32x16_bf16 v[80:95], v[40:43], v[228:231], v[80:95]
    v_rcp_f32 v106, v106
    v_rcp_f32 v107, v107
    v_rcp_f32 v108, v108
    v_rcp_f32 v109, v109
    v_rcp_f32 v110, v110
    v_rcp_f32 v111, v111
    s_setprio 0
    v_and_b32 v52, v55, v48
    v_fmac_f32 v52, v96, v112
    v_fmac_f32 v52, v97, v113
    v_fmac_f32 v52, v98, v114
    v_fmac_f32 v52, v99, v115
    v_and_b32 v53, v52, v49
    v_fmac_f32 v53, v100, v116
    v_fmac_f32 v53, v101, v117
    v_fmac_f32 v53, v102, v118
    v_fmac_f32 v53, v103, v119
    v_and_b32 v54, v53, v50
    v_fmac_f32 v54, v104, v120
    v_fmac_f32 v54, v105, v121
    v_fmac_f32 v54, v106, v122
    v_fmac_f32 v54, v107, v123
    v_and_b32 v55, v54, v51
    v_fmac_f32 v55, v108, v124
    v_fmac_f32 v55, v109, v125
    v_fmac_f32 v55, v110, v126
    v_fmac_f32 v55, v111, v127
    s_sub_u32 s21, s21, 1
    s_cmp_eq_u32 s21, 0
    s_cbranch_scc1 P2_FLUSH
    s_setprio 1
    v_exp_f32 v64, v64
    v_mfma_f32_32x32x16_bf16 v[96:111], v[44:47], v[252:255], 0
    v_exp_f32 v65, v65
    s_cmp_gt_u32 s21, 3
    s_cselect_b32 s58, s18, 0
    buffer_load_dwordx4 v[144:147], v176, s[56:59], 0 offen sc1
    ds_write_b32 v148, v52 offset:54276
    ds_write_b32 v149, v53 offset:54276
    ds_write_b32 v150, v54 offset:54276
    ds_write_b32 v151, v55 offset:54276
    ds_read_b128 v[48:51], v179 offset:37392
    v_exp_f32 v66, v66
    v_exp_f32 v67, v67
    v_mfma_f32_32x32x16_bf16 v[96:111], v[28:31], v[200:203], v[96:111]
    v_exp_f32 v68, v68
    v_exp_f32 v69, v69
    v_exp_f32 v70, v70
    v_mfma_f32_32x32x16_bf16 v[96:111], v[32:35], v[204:207], v[96:111]
    v_exp_f32 v71, v71
    v_exp_f32 v72, v72
    v_exp_f32 v73, v73
    v_mfma_f32_32x32x16_bf16 v[96:111], v[36:39], v[208:211], v[96:111]
    v_exp_f32 v74, v74
    v_exp_f32 v75, v75
    v_exp_f32 v76, v76
    v_mfma_f32_32x32x16_bf16 v[96:111], v[40:43], v[212:215], v[96:111]
    v_exp_f32 v77, v77
    v_exp_f32 v78, v78
    v_exp_f32 v79, v79
    s_setprio 0
    v_add_u32 v148, v152, v183
    v_add_u32 v149, v153, v183
    v_add_u32 v150, v154, v183
    v_add_u32 v151, v155, v183
    s_waitcnt lgkmcnt(5)
    v_fma_f32 v64, v64, v156, 1.0
    v_fma_f32 v65, v65, v156, 1.0
    v_fma_f32 v66, v66, v156, 1.0
    v_fma_f32 v67, v67, v156, 1.0
    v_fma_f32 v68, v68, v158, 1.0
    v_fma_f32 v69, v69, v158, 1.0
    v_fma_f32 v70, v70, v158, 1.0
    v_fma_f32 v71, v71, v158, 1.0
    v_fma_f32 v72, v72, v160, 1.0
    v_fma_f32 v73, v73, v160, 1.0
    v_fma_f32 v74, v74, v160, 1.0
    v_fma_f32 v75, v75, v160, 1.0
    v_fma_f32 v76, v76, v162, 1.0
    v_fma_f32 v77, v77, v162, 1.0
    v_fma_f32 v78, v78, v162, 1.0
    v_fma_f32 v79, v79, v162, 1.0
    s_setprio 1
    v_rcp_f32 v64, v64
    v_mfma_f32_32x32x16_bf16 v[112:127], v[28:31], v[232:235], 0
    v_rcp_f32 v65, v65
    s_waitcnt vmcnt(6)
    ds_read_b128 v[128:131], v172 offset:0
    ds_read_b128 v[132:135], v173 offset:0
    ds_read_b128 v[136:139], v174 offset:0
    ds_read_b128 v[140:143], v175 offset:0
    ds_read_b128 v[164:167], v177 offset:768
    ds_read_b128 v[152:155], v179 offset:33312
    ds_read_b32 v176, v178 offset:17216
    s_cmp_gt_u32 s21, 3
    s_cselect_b32 s38, s19, 0
    s_add_u32 m0, s20, 0
    v_rcp_f32 v66, v66
    v_rcp_f32 v67, v67
    v_mfma_f32_32x32x16_bf16 v[112:127], v[32:35], v[236:239], v[112:127]
    v_rcp_f32 v68, v68
    v_rcp_f32 v69, v69
    v_rcp_f32 v70, v70
    v_mfma_f32_32x32x16_bf16 v[112:127], v[36:39], v[240:243], v[112:127]
    v_rcp_f32 v71, v71
    v_rcp_f32 v72, v72
    v_rcp_f32 v73, v73
    v_mfma_f32_32x32x16_bf16 v[112:127], v[40:43], v[244:247], v[112:127]
    v_rcp_f32 v74, v74
    v_rcp_f32 v75, v75
    v_rcp_f32 v76, v76
    v_rcp_f32 v77, v77
    v_rcp_f32 v78, v78
    v_rcp_f32 v79, v79
    s_setprio 0
    s_waitcnt lgkmcnt(7)
    v_and_b32 v168, v171, v48
    v_fmac_f32 v168, v64, v80
    v_fmac_f32 v168, v65, v81
    v_fmac_f32 v168, v66, v82
    v_fmac_f32 v168, v67, v83
    v_and_b32 v169, v168, v49
    v_fmac_f32 v169, v68, v84
    v_fmac_f32 v169, v69, v85
    v_fmac_f32 v169, v70, v86
    v_fmac_f32 v169, v71, v87
    v_and_b32 v170, v169, v50
    v_fmac_f32 v170, v72, v88
    v_fmac_f32 v170, v73, v89
    v_fmac_f32 v170, v74, v90
    v_fmac_f32 v170, v75, v91
    v_and_b32 v171, v170, v51
    v_fmac_f32 v171, v76, v92
    v_fmac_f32 v171, v77, v93
    v_fmac_f32 v171, v78, v94
    v_fmac_f32 v171, v79, v95
    s_waitcnt lgkmcnt(2)
    v_or_b32 v164, v164, v180
    v_or_b32 v165, v165, v10
    v_or_b32 v166, v166, v11
    v_or_b32 v167, v167, v12
    s_setprio 1
    v_exp_f32 v96, v96
    v_mfma_f32_32x32x16_bf16 v[64:79], v[24:27], v[248:251], 0
    v_exp_f32 v97, v97
    buffer_load_dwordx4 v164, s[36:39], 0 offen  lds
    s_add_u32 m0, s20, 1024
    ds_write_b32 v148, v168 offset:54272
    buffer_load_dwordx4 v165, s[36:39], 0 offen  lds
    s_add_u32 m0, s20, 2048
    ds_write_b32 v149, v169 offset:54272
    buffer_load_dwordx4 v166, s[36:39], 0 offen  lds
    s_add_u32 m0, s20, 3072
    ds_write_b32 v150, v170 offset:54272
    buffer_load_dwordx4 v167, s[36:39], 0 offen  lds
    ds_write_b32 v151, v171 offset:54272
    v_exp_f32 v98, v98
    v_exp_f32 v99, v99
    v_mfma_f32_32x32x16_bf16 v[64:79], v[128:131], v[184:187], v[64:79]
    v_exp_f32 v100, v100
    v_exp_f32 v101, v101
    v_exp_f32 v102, v102
    v_mfma_f32_32x32x16_bf16 v[64:79], v[132:135], v[188:191], v[64:79]
    v_exp_f32 v103, v103
    v_exp_f32 v104, v104
    v_exp_f32 v105, v105
    v_mfma_f32_32x32x16_bf16 v[64:79], v[136:139], v[192:195], v[64:79]
    v_exp_f32 v106, v106
    v_exp_f32 v107, v107
    v_exp_f32 v108, v108
    v_mfma_f32_32x32x16_bf16 v[64:79], v[140:143], v[196:199], v[64:79]
    v_exp_f32 v109, v109
    v_exp_f32 v110, v110
    v_exp_f32 v111, v111
    s_setprio 0
    v_fma_f32 v96, v96, v157, 1.0
    v_fma_f32 v97, v97, v157, 1.0
    v_fma_f32 v98, v98, v157, 1.0
    v_fma_f32 v99, v99, v157, 1.0
    v_fma_f32 v100, v100, v159, 1.0
    v_fma_f32 v101, v101, v159, 1.0
    v_fma_f32 v102, v102, v159, 1.0
    v_fma_f32 v103, v103, v159, 1.0
    v_fma_f32 v104, v104, v161, 1.0
    v_fma_f32 v105, v105, v161, 1.0
    v_fma_f32 v106, v106, v161, 1.0
    v_fma_f32 v107, v107, v161, 1.0
    v_fma_f32 v108, v108, v163, 1.0
    v_fma_f32 v109, v109, v163, 1.0
    v_fma_f32 v110, v110, v163, 1.0
    v_fma_f32 v111, v111, v163, 1.0
    s_waitcnt lgkmcnt(4)
    v_add_u32 v60, v152, v181
    v_add_u32 v61, v153, v181
    v_add_u32 v62, v154, v181
    v_add_u32 v63, v155, v181
    v_add_u32 v176, v176, v182
    s_setprio 1
    v_rcp_f32 v96, v96
    v_mfma_f32_32x32x16_bf16 v[80:95], v[128:131], v[216:219], 0
    v_rcp_f32 v97, v97
    ds_read_b64 v[156:157], v60 offset:41472
    ds_read_b64 v[158:159], v61 offset:41472
    ds_read_b64 v[160:161], v62 offset:41472
    ds_read_b64 v[162:163], v63 offset:41472
    v_rcp_f32 v98, v98
    v_rcp_f32 v99, v99
    v_mfma_f32_32x32x16_bf16 v[80:95], v[132:135], v[220:223], v[80:95]
    v_rcp_f32 v100, v100
    v_rcp_f32 v101, v101
    v_rcp_f32 v102, v102
    v_mfma_f32_32x32x16_bf16 v[80:95], v[136:139], v[224:227], v[80:95]
    v_rcp_f32 v103, v103
    v_rcp_f32 v104, v104
    v_rcp_f32 v105, v105
    v_mfma_f32_32x32x16_bf16 v[80:95], v[140:143], v[228:231], v[80:95]
    v_rcp_f32 v106, v106
    v_rcp_f32 v107, v107
    v_rcp_f32 v108, v108
    v_rcp_f32 v109, v109
    v_rcp_f32 v110, v110
    v_rcp_f32 v111, v111
    s_setprio 0
    v_and_b32 v52, v55, v48
    v_fmac_f32 v52, v96, v112
    v_fmac_f32 v52, v97, v113
    v_fmac_f32 v52, v98, v114
    v_fmac_f32 v52, v99, v115
    v_and_b32 v53, v52, v49
    v_fmac_f32 v53, v100, v116
    v_fmac_f32 v53, v101, v117
    v_fmac_f32 v53, v102, v118
    v_fmac_f32 v53, v103, v119
    v_and_b32 v54, v53, v50
    v_fmac_f32 v54, v104, v120
    v_fmac_f32 v54, v105, v121
    v_fmac_f32 v54, v106, v122
    v_fmac_f32 v54, v107, v123
    v_and_b32 v55, v54, v51
    v_fmac_f32 v55, v108, v124
    v_fmac_f32 v55, v109, v125
    v_fmac_f32 v55, v110, v126
    v_fmac_f32 v55, v111, v127
    s_sub_u32 s21, s21, 1
    s_cmp_eq_u32 s21, 0
    s_cbranch_scc1 P2_FLUSH
    s_setprio 1
    v_exp_f32 v64, v64
    v_mfma_f32_32x32x16_bf16 v[96:111], v[24:27], v[252:255], 0
    v_exp_f32 v65, v65
    s_cmp_gt_u32 s21, 3
    s_cselect_b32 s58, s18, 0
    buffer_load_dwordx4 v[44:47], v176, s[56:59], 0 offen sc1
    ds_write_b32 v148, v52 offset:54276
    ds_write_b32 v149, v53 offset:54276
    ds_write_b32 v150, v54 offset:54276
    ds_write_b32 v151, v55 offset:54276
    ds_read_b128 v[48:51], v179 offset:37408
    v_exp_f32 v66, v66
    v_exp_f32 v67, v67
    v_mfma_f32_32x32x16_bf16 v[96:111], v[128:131], v[200:203], v[96:111]
    v_exp_f32 v68, v68
    v_exp_f32 v69, v69
    v_exp_f32 v70, v70
    v_mfma_f32_32x32x16_bf16 v[96:111], v[132:135], v[204:207], v[96:111]
    v_exp_f32 v71, v71
    v_exp_f32 v72, v72
    v_exp_f32 v73, v73
    v_mfma_f32_32x32x16_bf16 v[96:111], v[136:139], v[208:211], v[96:111]
    v_exp_f32 v74, v74
    v_exp_f32 v75, v75
    v_exp_f32 v76, v76
    v_mfma_f32_32x32x16_bf16 v[96:111], v[140:143], v[212:215], v[96:111]
    v_exp_f32 v77, v77
    v_exp_f32 v78, v78
    v_exp_f32 v79, v79
    s_setprio 0
    v_add_u32 v148, v152, v183
    v_add_u32 v149, v153, v183
    v_add_u32 v150, v154, v183
    v_add_u32 v151, v155, v183
    s_waitcnt lgkmcnt(5)
    v_fma_f32 v64, v64, v156, 1.0
    v_fma_f32 v65, v65, v156, 1.0
    v_fma_f32 v66, v66, v156, 1.0
    v_fma_f32 v67, v67, v156, 1.0
    v_fma_f32 v68, v68, v158, 1.0
    v_fma_f32 v69, v69, v158, 1.0
    v_fma_f32 v70, v70, v158, 1.0
    v_fma_f32 v71, v71, v158, 1.0
    v_fma_f32 v72, v72, v160, 1.0
    v_fma_f32 v73, v73, v160, 1.0
    v_fma_f32 v74, v74, v160, 1.0
    v_fma_f32 v75, v75, v160, 1.0
    v_fma_f32 v76, v76, v162, 1.0
    v_fma_f32 v77, v77, v162, 1.0
    v_fma_f32 v78, v78, v162, 1.0
    v_fma_f32 v79, v79, v162, 1.0
    s_setprio 1
    v_rcp_f32 v64, v64
    v_mfma_f32_32x32x16_bf16 v[112:127], v[128:131], v[232:235], 0
    v_rcp_f32 v65, v65
    s_waitcnt vmcnt(6)
    ds_read_b128 v[28:31], v172 offset:4096
    ds_read_b128 v[32:35], v173 offset:4096
    ds_read_b128 v[36:39], v174 offset:4096
    ds_read_b128 v[40:43], v175 offset:4096
    ds_read_b128 v[164:167], v177 offset:832
    ds_read_b128 v[152:155], v179 offset:33328
    ds_read_b32 v176, v178 offset:17280
    s_cmp_gt_u32 s21, 3
    s_cselect_b32 s38, s19, 0
    s_add_u32 m0, s20, 4096
    v_rcp_f32 v66, v66
    v_rcp_f32 v67, v67
    v_mfma_f32_32x32x16_bf16 v[112:127], v[132:135], v[236:239], v[112:127]
    v_rcp_f32 v68, v68
    v_rcp_f32 v69, v69
    v_rcp_f32 v70, v70
    v_mfma_f32_32x32x16_bf16 v[112:127], v[136:139], v[240:243], v[112:127]
    v_rcp_f32 v71, v71
    v_rcp_f32 v72, v72
    v_rcp_f32 v73, v73
    v_mfma_f32_32x32x16_bf16 v[112:127], v[140:143], v[244:247], v[112:127]
    v_rcp_f32 v74, v74
    v_rcp_f32 v75, v75
    v_rcp_f32 v76, v76
    v_rcp_f32 v77, v77
    v_rcp_f32 v78, v78
    v_rcp_f32 v79, v79
    s_setprio 0
    s_waitcnt lgkmcnt(7)
    v_and_b32 v168, v171, v48
    v_fmac_f32 v168, v64, v80
    v_fmac_f32 v168, v65, v81
    v_fmac_f32 v168, v66, v82
    v_fmac_f32 v168, v67, v83
    v_and_b32 v169, v168, v49
    v_fmac_f32 v169, v68, v84
    v_fmac_f32 v169, v69, v85
    v_fmac_f32 v169, v70, v86
    v_fmac_f32 v169, v71, v87
    v_and_b32 v170, v169, v50
    v_fmac_f32 v170, v72, v88
    v_fmac_f32 v170, v73, v89
    v_fmac_f32 v170, v74, v90
    v_fmac_f32 v170, v75, v91
    v_and_b32 v171, v170, v51
    v_fmac_f32 v171, v76, v92
    v_fmac_f32 v171, v77, v93
    v_fmac_f32 v171, v78, v94
    v_fmac_f32 v171, v79, v95
    s_waitcnt lgkmcnt(2)
    v_or_b32 v164, v164, v180
    v_or_b32 v165, v165, v10
    v_or_b32 v166, v166, v11
    v_or_b32 v167, v167, v12
    s_setprio 1
    v_exp_f32 v96, v96
    v_mfma_f32_32x32x16_bf16 v[64:79], v[56:59], v[248:251], 0
    v_exp_f32 v97, v97
    buffer_load_dwordx4 v164, s[36:39], 0 offen  lds
    s_add_u32 m0, s20, 5120
    ds_write_b32 v148, v168 offset:54272
    buffer_load_dwordx4 v165, s[36:39], 0 offen  lds
    s_add_u32 m0, s20, 6144
    ds_write_b32 v149, v169 offset:54272
    buffer_load_dwordx4 v166, s[36:39], 0 offen  lds
    s_add_u32 m0, s20, 7168
    ds_write_b32 v150, v170 offset:54272
    buffer_load_dwordx4 v167, s[36:39], 0 offen  lds
    ds_write_b32 v151, v171 offset:54272
    v_exp_f32 v98, v98
    v_exp_f32 v99, v99
    v_mfma_f32_32x32x16_bf16 v[64:79], v[28:31], v[184:187], v[64:79]
    v_exp_f32 v100, v100
    v_exp_f32 v101, v101
    v_exp_f32 v102, v102
    v_mfma_f32_32x32x16_bf16 v[64:79], v[32:35], v[188:191], v[64:79]
    v_exp_f32 v103, v103
    v_exp_f32 v104, v104
    v_exp_f32 v105, v105
    v_mfma_f32_32x32x16_bf16 v[64:79], v[36:39], v[192:195], v[64:79]
    v_exp_f32 v106, v106
    v_exp_f32 v107, v107
    v_exp_f32 v108, v108
    v_mfma_f32_32x32x16_bf16 v[64:79], v[40:43], v[196:199], v[64:79]
    v_exp_f32 v109, v109
    v_exp_f32 v110, v110
    v_exp_f32 v111, v111
    s_setprio 0
    v_fma_f32 v96, v96, v157, 1.0
    v_fma_f32 v97, v97, v157, 1.0
    v_fma_f32 v98, v98, v157, 1.0
    v_fma_f32 v99, v99, v157, 1.0
    v_fma_f32 v100, v100, v159, 1.0
    v_fma_f32 v101, v101, v159, 1.0
    v_fma_f32 v102, v102, v159, 1.0
    v_fma_f32 v103, v103, v159, 1.0
    v_fma_f32 v104, v104, v161, 1.0
    v_fma_f32 v105, v105, v161, 1.0
    v_fma_f32 v106, v106, v161, 1.0
    v_fma_f32 v107, v107, v161, 1.0
    v_fma_f32 v108, v108, v163, 1.0
    v_fma_f32 v109, v109, v163, 1.0
    v_fma_f32 v110, v110, v163, 1.0
    v_fma_f32 v111, v111, v163, 1.0
    s_waitcnt lgkmcnt(4)
    v_add_u32 v60, v152, v181
    v_add_u32 v61, v153, v181
    v_add_u32 v62, v154, v181
    v_add_u32 v63, v155, v181
    v_add_u32 v176, v176, v182
    s_setprio 1
    v_rcp_f32 v96, v96
    v_mfma_f32_32x32x16_bf16 v[80:95], v[28:31], v[216:219], 0
    v_rcp_f32 v97, v97
    ds_read_b64 v[156:157], v60 offset:41472
    ds_read_b64 v[158:159], v61 offset:41472
    ds_read_b64 v[160:161], v62 offset:41472
    ds_read_b64 v[162:163], v63 offset:41472
    v_rcp_f32 v98, v98
    v_rcp_f32 v99, v99
    v_mfma_f32_32x32x16_bf16 v[80:95], v[32:35], v[220:223], v[80:95]
    v_rcp_f32 v100, v100
    v_rcp_f32 v101, v101
    v_rcp_f32 v102, v102
    v_mfma_f32_32x32x16_bf16 v[80:95], v[36:39], v[224:227], v[80:95]
    v_rcp_f32 v103, v103
    v_rcp_f32 v104, v104
    v_rcp_f32 v105, v105
    v_mfma_f32_32x32x16_bf16 v[80:95], v[40:43], v[228:231], v[80:95]
    v_rcp_f32 v106, v106
    v_rcp_f32 v107, v107
    v_rcp_f32 v108, v108
    v_rcp_f32 v109, v109
    v_rcp_f32 v110, v110
    v_rcp_f32 v111, v111
    s_setprio 0
    v_and_b32 v52, v55, v48
    v_fmac_f32 v52, v96, v112
    v_fmac_f32 v52, v97, v113
    v_fmac_f32 v52, v98, v114
    v_fmac_f32 v52, v99, v115
    v_and_b32 v53, v52, v49
    v_fmac_f32 v53, v100, v116
    v_fmac_f32 v53, v101, v117
    v_fmac_f32 v53, v102, v118
    v_fmac_f32 v53, v103, v119
    v_and_b32 v54, v53, v50
    v_fmac_f32 v54, v104, v120
    v_fmac_f32 v54, v105, v121
    v_fmac_f32 v54, v106, v122
    v_fmac_f32 v54, v107, v123
    v_and_b32 v55, v54, v51
    v_fmac_f32 v55, v108, v124
    v_fmac_f32 v55, v109, v125
    v_fmac_f32 v55, v110, v126
    v_fmac_f32 v55, v111, v127
    s_sub_u32 s21, s21, 1
    s_cmp_eq_u32 s21, 0
    s_cbranch_scc1 P2_FLUSH
    s_setprio 1
    v_exp_f32 v64, v64
    v_mfma_f32_32x32x16_bf16 v[96:111], v[56:59], v[252:255], 0
    v_exp_f32 v65, v65
    s_cmp_gt_u32 s21, 3
    s_cselect_b32 s58, s18, 0
    buffer_load_dwordx4 v[24:27], v176, s[56:59], 0 offen sc1
    ds_write_b32 v148, v52 offset:54276
    ds_write_b32 v149, v53 offset:54276
    ds_write_b32 v150, v54 offset:54276
    ds_write_b32 v151, v55 offset:54276
    ds_read_b128 v[48:51], v179 offset:37424
    v_exp_f32 v66, v66
    v_exp_f32 v67, v67
    v_mfma_f32_32x32x16_bf16 v[96:111], v[28:31], v[200:203], v[96:111]
    v_exp_f32 v68, v68
    v_exp_f32 v69, v69
    v_exp_f32 v70, v70
    v_mfma_f32_32x32x16_bf16 v[96:111], v[32:35], v[204:207], v[96:111]
    v_exp_f32 v71, v71
    v_exp_f32 v72, v72
    v_exp_f32 v73, v73
    v_mfma_f32_32x32x16_bf16 v[96:111], v[36:39], v[208:211], v[96:111]
    v_exp_f32 v74, v74
    v_exp_f32 v75, v75
    v_exp_f32 v76, v76
    v_mfma_f32_32x32x16_bf16 v[96:111], v[40:43], v[212:215], v[96:111]
    v_exp_f32 v77, v77
    v_exp_f32 v78, v78
    v_exp_f32 v79, v79
    s_setprio 0
    v_add_u32 v148, v152, v183
    v_add_u32 v149, v153, v183
    v_add_u32 v150, v154, v183
    v_add_u32 v151, v155, v183
    s_waitcnt lgkmcnt(5)
    v_fma_f32 v64, v64, v156, 1.0
    v_fma_f32 v65, v65, v156, 1.0
    v_fma_f32 v66, v66, v156, 1.0
    v_fma_f32 v67, v67, v156, 1.0
    v_fma_f32 v68, v68, v158, 1.0
    v_fma_f32 v69, v69, v158, 1.0
    v_fma_f32 v70, v70, v158, 1.0
    v_fma_f32 v71, v71, v158, 1.0
    v_fma_f32 v72, v72, v160, 1.0
    v_fma_f32 v73, v73, v160, 1.0
    v_fma_f32 v74, v74, v160, 1.0
    v_fma_f32 v75, v75, v160, 1.0
    v_fma_f32 v76, v76, v162, 1.0
    v_fma_f32 v77, v77, v162, 1.0
    v_fma_f32 v78, v78, v162, 1.0
    v_fma_f32 v79, v79, v162, 1.0
    s_setprio 1
    v_rcp_f32 v64, v64
    v_mfma_f32_32x32x16_bf16 v[112:127], v[28:31], v[232:235], 0
    v_rcp_f32 v65, v65
    s_waitcnt vmcnt(6)
    ds_read_b128 v[128:131], v172 offset:0
    ds_read_b128 v[132:135], v173 offset:0
    ds_read_b128 v[136:139], v174 offset:0
    ds_read_b128 v[140:143], v175 offset:0
    ds_read_b128 v[164:167], v177 offset:896
    ds_read_b128 v[152:155], v179 offset:33344
    ds_read_b32 v176, v178 offset:17344
    s_cmp_gt_u32 s21, 3
    s_cselect_b32 s38, s19, 0
    s_add_u32 m0, s20, 0
    v_rcp_f32 v66, v66
    v_rcp_f32 v67, v67
    v_mfma_f32_32x32x16_bf16 v[112:127], v[32:35], v[236:239], v[112:127]
    v_rcp_f32 v68, v68
    v_rcp_f32 v69, v69
    v_rcp_f32 v70, v70
    v_mfma_f32_32x32x16_bf16 v[112:127], v[36:39], v[240:243], v[112:127]
    v_rcp_f32 v71, v71
    v_rcp_f32 v72, v72
    v_rcp_f32 v73, v73
    v_mfma_f32_32x32x16_bf16 v[112:127], v[40:43], v[244:247], v[112:127]
    v_rcp_f32 v74, v74
    v_rcp_f32 v75, v75
    v_rcp_f32 v76, v76
    v_rcp_f32 v77, v77
    v_rcp_f32 v78, v78
    v_rcp_f32 v79, v79
    s_setprio 0
    s_waitcnt lgkmcnt(7)
    v_and_b32 v168, v171, v48
    v_fmac_f32 v168, v64, v80
    v_fmac_f32 v168, v65, v81
    v_fmac_f32 v168, v66, v82
    v_fmac_f32 v168, v67, v83
    v_and_b32 v169, v168, v49
    v_fmac_f32 v169, v68, v84
    v_fmac_f32 v169, v69, v85
    v_fmac_f32 v169, v70, v86
    v_fmac_f32 v169, v71, v87
    v_and_b32 v170, v169, v50
    v_fmac_f32 v170, v72, v88
    v_fmac_f32 v170, v73, v89
    v_fmac_f32 v170, v74, v90
    v_fmac_f32 v170, v75, v91
    v_and_b32 v171, v170, v51
    v_fmac_f32 v171, v76, v92
    v_fmac_f32 v171, v77, v93
    v_fmac_f32 v171, v78, v94
    v_fmac_f32 v171, v79, v95
    s_waitcnt lgkmcnt(2)
    v_or_b32 v164, v164, v180
    v_or_b32 v165, v165, v10
    v_or_b32 v166, v166, v11
    v_or_b32 v167, v167, v12
    s_setprio 1
    v_exp_f32 v96, v96
    v_mfma_f32_32x32x16_bf16 v[64:79], v[144:147], v[248:251], 0
    v_exp_f32 v97, v97
    buffer_load_dwordx4 v164, s[36:39], 0 offen  lds
    s_add_u32 m0, s20, 1024
    ds_write_b32 v148, v168 offset:54272
    buffer_load_dwordx4 v165, s[36:39], 0 offen  lds
    s_add_u32 m0, s20, 2048
    ds_write_b32 v149, v169 offset:54272
    buffer_load_dwordx4 v166, s[36:39], 0 offen  lds
    s_add_u32 m0, s20, 3072
    ds_write_b32 v150, v170 offset:54272
    buffer_load_dwordx4 v167, s[36:39], 0 offen  lds
    ds_write_b32 v151, v171 offset:54272
    v_exp_f32 v98, v98
    v_exp_f32 v99, v99
    v_mfma_f32_32x32x16_bf16 v[64:79], v[128:131], v[184:187], v[64:79]
    v_exp_f32 v100, v100
    v_exp_f32 v101, v101
    v_exp_f32 v102, v102
    v_mfma_f32_32x32x16_bf16 v[64:79], v[132:135], v[188:191], v[64:79]
    v_exp_f32 v103, v103
    v_exp_f32 v104, v104
    v_exp_f32 v105, v105
    v_mfma_f32_32x32x16_bf16 v[64:79], v[136:139], v[192:195], v[64:79]
    v_exp_f32 v106, v106
    v_exp_f32 v107, v107
    v_exp_f32 v108, v108
    v_mfma_f32_32x32x16_bf16 v[64:79], v[140:143], v[196:199], v[64:79]
    v_exp_f32 v109, v109
    v_exp_f32 v110, v110
    v_exp_f32 v111, v111
    s_setprio 0
    v_fma_f32 v96, v96, v157, 1.0
    v_fma_f32 v97, v97, v157, 1.0
    v_fma_f32 v98, v98, v157, 1.0
    v_fma_f32 v99, v99, v157, 1.0
    v_fma_f32 v100, v100, v159, 1.0
    v_fma_f32 v101, v101, v159, 1.0
    v_fma_f32 v102, v102, v159, 1.0
    v_fma_f32 v103, v103, v159, 1.0
    v_fma_f32 v104, v104, v161, 1.0
    v_fma_f32 v105, v105, v161, 1.0
    v_fma_f32 v106, v106, v161, 1.0
    v_fma_f32 v107, v107, v161, 1.0
    v_fma_f32 v108, v108, v163, 1.0
    v_fma_f32 v109, v109, v163, 1.0
    v_fma_f32 v110, v110, v163, 1.0
    v_fma_f32 v111, v111, v163, 1.0
    s_waitcnt lgkmcnt(4)
    v_add_u32 v60, v152, v181
    v_add_u32 v61, v153, v181
    v_add_u32 v62, v154, v181
    v_add_u32 v63, v155, v181
    v_add_u32 v176, v176, v182
    s_setprio 1
    v_rcp_f32 v96, v96
    v_mfma_f32_32x32x16_bf16 v[80:95], v[128:131], v[216:219], 0
    v_rcp_f32 v97, v97
    ds_read_b64 v[156:157], v60 offset:41472
    ds_read_b64 v[158:159], v61 offset:41472
    ds_read_b64 v[160:161], v62 offset:41472
    ds_read_b64 v[162:163], v63 offset:41472
    v_rcp_f32 v98, v98
    v_rcp_f32 v99, v99
    v_mfma_f32_32x32x16_bf16 v[80:95], v[132:135], v[220:223], v[80:95]
    v_rcp_f32 v100, v100
    v_rcp_f32 v101, v101
    v_rcp_f32 v102, v102
    v_mfma_f32_32x32x16_bf16 v[80:95], v[136:139], v[224:227], v[80:95]
    v_rcp_f32 v103, v103
    v_rcp_f32 v104, v104
    v_rcp_f32 v105, v105
    v_mfma_f32_32x32x16_bf16 v[80:95], v[140:143], v[228:231], v[80:95]
    v_rcp_f32 v106, v106
    v_rcp_f32 v107, v107
    v_rcp_f32 v108, v108
    v_rcp_f32 v109, v109
    v_rcp_f32 v110, v110
    v_rcp_f32 v111, v111
    s_setprio 0
    v_and_b32 v52, v55, v48
    v_fmac_f32 v52, v96, v112
    v_fmac_f32 v52, v97, v113
    v_fmac_f32 v52, v98, v114
    v_fmac_f32 v52, v99, v115
    v_and_b32 v53, v52, v49
    v_fmac_f32 v53, v100, v116
    v_fmac_f32 v53, v101, v117
    v_fmac_f32 v53, v102, v118
    v_fmac_f32 v53, v103, v119
    v_and_b32 v54, v53, v50
    v_fmac_f32 v54, v104, v120
    v_fmac_f32 v54, v105, v121
    v_fmac_f32 v54, v106, v122
    v_fmac_f32 v54, v107, v123
    v_and_b32 v55, v54, v51
    v_fmac_f32 v55, v108, v124
    v_fmac_f32 v55, v109, v125
    v_fmac_f32 v55, v110, v126
    v_fmac_f32 v55, v111, v127
    v_add_u32 v177, 256, v177
    v_add_u32 v178, 256, v178
    v_add_u32 v179, 64, v179
    s_sub_u32 s21, s21, 1
    s_cmp_lg_u32 s21, 0
    s_cbranch_scc1 P2_LOOPF
    s_branch P2_FLUSH
P2_SAFE:
    s_cmp_gt_u32 s21, 2
    s_cselect_b32 s58, s18, 0
    buffer_load_dwordx4 v[24:27], v5, s[56:59], 0 offen
    v_mov_b32 v176, v6
    s_waitcnt vmcnt(0)
P2_LOOPS:
    s_waitcnt lgkmcnt(0)
    v_fmamk_f32 v64, v64, 0xbfb8aa3b, v156
    v_fmamk_f32 v65, v65, 0xbfb8aa3b, v156
    v_fmamk_f32 v66, v66, 0xbfb8aa3b, v156
    v_fmamk_f32 v67, v67, 0xbfb8aa3b, v156
    v_fmamk_f32 v68, v68, 0xbfb8aa3b, v158
    v_fmamk_f32 v69, v69, 0xbfb8aa3b, v158
    v_fmamk_f32 v70, v70, 0xbfb8aa3b, v158
    v_fmamk_f32 v71, v71, 0xbfb8aa3b, v158
    v_fmamk_f32 v72, v72, 0xbfb8aa3b, v160
    v_fmamk_f32 v73, v73, 0xbfb8aa3b, v160
    v_fmamk_f32 v74, v74, 0xbfb8aa3b, v160
    v_fmamk_f32 v75, v75, 0xbfb8aa3b, v160
    v_fmamk_f32 v76, v76, 0xbfb8aa3b, v162
    v_fmamk_f32 v77, v77, 0xbfb8aa3b, v162
    v_fmamk_f32 v78, v78, 0xbfb8aa3b, v162
    v_fmamk_f32 v79, v79, 0xbfb8aa3b, v162
    s_setprio 1
    v_exp_f32 v64, v64
    v_mfma_f32_32x32x16_bf16 v[96:111], v[144:147], v[252:255], 0
    v_exp_f32 v65, v65
    s_cmp_gt_u32 s21, 3
    s_cselect_b32 s58, s18, 0
    buffer_load_dwordx4 v[56:59], v176, s[56:59], 0 offen sc1
    ds_write_b32 v148, v52 offset:54276
    ds_write_b32 v149, v53 offset:54276
    ds_write_b32 v150, v54 offset:54276
    ds_write_b32 v151, v55 offset:54276
    ds_read_b128 v[48:51], v179 offset:37376
    v_exp_f32 v66, v66
    v_exp_f32 v67, v67
    v_mfma_f32_32x32x16_bf16 v[96:111], v[128:131], v[200:203], v[96:111]
    v_exp_f32 v68, v68
    v_exp_f32 v69, v69
    v_exp_f32 v70, v70
    v_mfma_f32_32x32x16_bf16 v[96:111], v[132:135], v[204:207], v[96:111]
    v_exp_f32 v71, v71
    v_exp_f32 v72, v72
    v_exp_f32 v73, v73
    v_mfma_f32_32x32x16_bf16 v[96:111], v[136:139], v[208:211], v[96:111]
    v_exp_f32 v74, v74
    v_exp_f32 v75, v75
    v_exp_f32 v76, v76
    v_mfma_f32_32x32x16_bf16 v[96:111], v[140:143], v[212:215], v[96:111]
    v_exp_f32 v77, v77
    v_exp_f32 v78, v78
    v_exp_f32 v79, v79
    s_setprio 0
    v_add_u32 v148, v152, v183
    v_add_u32 v149, v153, v183
    v_add_u32 v150, v154, v183
    v_add_u32 v151, v155, v183
    v_add_f32 v64, 1.0, v64
    v_add_f32 v65, 1.0, v65
    v_add_f32 v66, 1.0, v66
    v_add_f32 v67, 1.0, v67
    v_add_f32 v68, 1.0, v68
    v_add_f32 v69, 1.0, v69
    v_add_f32 v70, 1.0, v70
    v_add_f32 v71, 1.0, v71
    v_add_f32 v72, 1.0, v72
    v_add_f32 v73, 1.0, v73
    v_add_f32 v74, 1.0, v74
    v_add_f32 v75, 1.0, v75
    v_add_f32 v76, 1.0, v76
    v_add_f32 v77, 1.0, v77
    v_add_f32 v78, 1.0, v78
    v_add_f32 v79, 1.0, v79
    s_setprio 1
    v_rcp_f32 v64, v64
    v_mfma_f32_32x32x16_bf16 v[112:127], v[128:131], v[232:235], 0
    v_rcp_f32 v65, v65
    s_waitcnt vmcnt(6)
    ds_read_b128 v[28:31], v172 offset:4096
    ds_read_b128 v[32:35], v173 offset:4096
    ds_read_b128 v[36:39], v174 offset:4096
    ds_read_b128 v[40:43], v175 offset:4096
    ds_read_b128 v[164:167], v177 offset:704
    ds_read_b128 v[152:155], v179 offset:33296
    ds_read_b32 v176, v178 offset:17152
    s_cmp_gt_u32 s21, 3
    s_cselect_b32 s38, s19, 0
    s_add_u32 m0, s20, 4096
    v_rcp_f32 v66, v66
    v_rcp_f32 v67, v67
    v_mfma_f32_32x32x16_bf16 v[112:127], v[132:135], v[236:239], v[112:127]
    v_rcp_f32 v68, v68
    v_rcp_f32 v69, v69
    v_rcp_f32 v70, v70
    v_mfma_f32_32x32x16_bf16 v[112:127], v[136:139], v[240:243], v[112:127]
    v_rcp_f32 v71, v71
    v_rcp_f32 v72, v72
    v_rcp_f32 v73, v73
    v_mfma_f32_32x32x16_bf16 v[112:127], v[140:143], v[244:247], v[112:127]
    v_rcp_f32 v74, v74
    v_rcp_f32 v75, v75
    v_rcp_f32 v76, v76
    v_rcp_f32 v77, v77
    v_rcp_f32 v78, v78
    v_rcp_f32 v79, v79
    s_setprio 0
    s_waitcnt lgkmcnt(7)
    v_and_b32 v168, v171, v48
    v_fmac_f32 v168, v64, v80
    v_fmac_f32 v168, v65, v81
    v_fmac_f32 v168, v66, v82
    v_fmac_f32 v168, v67, v83
    v_and_b32 v169, v168, v49
    v_fmac_f32 v169, v68, v84
    v_fmac_f32 v169, v69, v85
    v_fmac_f32 v169, v70, v86
    v_fmac_f32 v169, v71, v87
    v_and_b32 v170, v169, v50
    v_fmac_f32 v170, v72, v88
    v_fmac_f32 v170, v73, v89
    v_fmac_f32 v170, v74, v90
    v_fmac_f32 v170, v75, v91
    v_and_b32 v171, v170, v51
    v_fmac_f32 v171, v76, v92
    v_fmac_f32 v171, v77, v93
    v_fmac_f32 v171, v78, v94
    v_fmac_f32 v171, v79, v95
    s_waitcnt lgkmcnt(2)
    v_or_b32 v164, v164, v180
    v_or_b32 v165, v165, v10
    v_or_b32 v166, v166, v11
    v_or_b32 v167, v167, v12
    v_fmamk_f32 v96, v96, 0xbfb8aa3b, v157
    v_fmamk_f32 v97, v97, 0xbfb8aa3b, v157
    v_fmamk_f32 v98, v98, 0xbfb8aa3b, v157
    v_fmamk_f32 v99, v99, 0xbfb8aa3b, v157
    v_fmamk_f32 v100, v100, 0xbfb8aa3b, v159
    v_fmamk_f32 v101, v101, 0xbfb8aa3b, v159
    v_fmamk_f32 v102, v102, 0xbfb8aa3b, v159
    v_fmamk_f32 v103, v103, 0xbfb8aa3b, v159
    v_fmamk_f32 v104, v104, 0xbfb8aa3b, v161
    v_fmamk_f32 v105, v105, 0xbfb8aa3b, v161
    v_fmamk_f32 v106, v106, 0xbfb8aa3b, v161
    v_fmamk_f32 v107, v107, 0xbfb8aa3b, v161
    v_fmamk_f32 v108, v108, 0xbfb8aa3b, v163
    v_fmamk_f32 v109, v109, 0xbfb8aa3b, v163
    v_fmamk_f32 v110, v110, 0xbfb8aa3b, v163
    v_fmamk_f32 v111, v111, 0xbfb8aa3b, v163
    s_setprio 1
    v_exp_f32 v96, v96
    v_mfma_f32_32x32x16_bf16 v[64:79], v[44:47], v[248:251], 0
    v_exp_f32 v97, v97
    buffer_load_dwordx4 v164, s[36:39], 0 offen  lds
    s_add_u32 m0, s20, 5120
    ds_write_b32 v148, v168 offset:54272
    buffer_load_dwordx4 v165, s[36:39], 0 offen  lds
    s_add_u32 m0, s20, 6144
    ds_write_b32 v149, v169 offset:54272
    buffer_load_dwordx4 v166, s[36:39], 0 offen  lds
    s_add_u32 m0, s20, 7168
    ds_write_b32 v150, v170 offset:54272
    buffer_load_dwordx4 v167, s[36:39], 0 offen  lds
    ds_write_b32 v151, v171 offset:54272
    v_exp_f32 v98, v98
    v_exp_f32 v99, v99
    v_mfma_f32_32x32x16_bf16 v[64:79], v[28:31], v[184:187], v[64:79]
    v_exp_f32 v100, v100
    v_exp_f32 v101, v101
    v_exp_f32 v102, v102
    v_mfma_f32_32x32x16_bf16 v[64:79], v[32:35], v[188:191], v[64:79]
    v_exp_f32 v103, v103
    v_exp_f32 v104, v104
    v_exp_f32 v105, v105
    v_mfma_f32_32x32x16_bf16 v[64:79], v[36:39], v[192:195], v[64:79]
    v_exp_f32 v106, v106
    v_exp_f32 v107, v107
    v_exp_f32 v108, v108
    v_mfma_f32_32x32x16_bf16 v[64:79], v[40:43], v[196:199], v[64:79]
    v_exp_f32 v109, v109
    v_exp_f32 v110, v110
    v_exp_f32 v111, v111
    s_setprio 0
    v_add_f32 v96, 1.0, v96
    v_add_f32 v97, 1.0, v97
    v_add_f32 v98, 1.0, v98
    v_add_f32 v99, 1.0, v99
    v_add_f32 v100, 1.0, v100
    v_add_f32 v101, 1.0, v101
    v_add_f32 v102, 1.0, v102
    v_add_f32 v103, 1.0, v103
    v_add_f32 v104, 1.0, v104
    v_add_f32 v105, 1.0, v105
    v_add_f32 v106, 1.0, v106
    v_add_f32 v107, 1.0, v107
    v_add_f32 v108, 1.0, v108
    v_add_f32 v109, 1.0, v109
    v_add_f32 v110, 1.0, v110
    v_add_f32 v111, 1.0, v111
    s_waitcnt lgkmcnt(4)
    v_add_u32 v60, v152, v181
    v_add_u32 v61, v153, v181
    v_add_u32 v62, v154, v181
    v_add_u32 v63, v155, v181
    v_add_u32 v176, v176, v182
    s_setprio 1
    v_rcp_f32 v96, v96
    v_mfma_f32_32x32x16_bf16 v[80:95], v[28:31], v[216:219], 0
    v_rcp_f32 v97, v97
    ds_read_b64 v[156:157], v60 offset:41472
    ds_read_b64 v[158:159], v61 offset:41472
    ds_read_b64 v[160:161], v62 offset:41472
    ds_read_b64 v[162:163], v63 offset:41472
    v_rcp_f32 v98, v98
    v_rcp_f32 v99, v99
    v_mfma_f32_32x32x16_bf16 v[80:95], v[32:35], v[220:223], v[80:95]
    v_rcp_f32 v100, v100
    v_rcp_f32 v101, v101
    v_rcp_f32 v102, v102
    v_mfma_f32_32x32x16_bf16 v[80:95], v[36:39], v[224:227], v[80:95]
    v_rcp_f32 v103, v103
    v_rcp_f32 v104, v104
    v_rcp_f32 v105, v105
    v_mfma_f32_32x32x16_bf16 v[80:95], v[40:43], v[228:231], v[80:95]
    v_rcp_f32 v106, v106
    v_rcp_f32 v107, v107
    v_rcp_f32 v108, v108
    v_rcp_f32 v109, v109
    v_rcp_f32 v110, v110
    v_rcp_f32 v111, v111
    s_setprio 0
    v_and_b32 v52, v55, v48
    v_fmac_f32 v52, v96, v112
    v_fmac_f32 v52, v97, v113
    v_fmac_f32 v52, v98, v114
    v_fmac_f32 v52, v99, v115
    v_and_b32 v53, v52, v49
    v_fmac_f32 v53, v100, v116
    v_fmac_f32 v53, v101, v117
    v_fmac_f32 v53, v102, v118
    v_fmac_f32 v53, v103, v119
    v_and_b32 v54, v53, v50
    v_fmac_f32 v54, v104, v120
    v_fmac_f32 v54, v105, v121
    v_fmac_f32 v54, v106, v122
    v_fmac_f32 v54, v107, v123
    v_and_b32 v55, v54, v51
    v_fmac_f32 v55, v108, v124
    v_fmac_f32 v55, v109, v125
    v_fmac_f32 v55, v110, v126
    v_fmac_f32 v55, v111, v127
    s_sub_u32 s21, s21, 1
    s_cmp_eq_u32 s21, 0
    s_cbranch_scc1 P2_FLUSH
    s_waitcnt lgkmcnt(0)
    v_fmamk_f32 v64, v64, 0xbfb8aa3b, v156
    v_fmamk_f32 v65, v65, 0xbfb8aa3b, v156
    v_fmamk_f32 v66, v66, 0xbfb8aa3b, v156
    v_fmamk_f32 v67, v67, 0xbfb8aa3b, v156
    v_fmamk_f32 v68, v68, 0xbfb8aa3b, v158
    v_fmamk_f32 v69, v69, 0xbfb8aa3b, v158
    v_fmamk_f32 v70, v70, 0xbfb8aa3b, v158
    v_fmamk_f32 v71, v71, 0xbfb8aa3b, v158
    v_fmamk_f32 v72, v72, 0xbfb8aa3b, v160
    v_fmamk_f32 v73, v73, 0xbfb8aa3b, v160
    v_fmamk_f32 v74, v74, 0xbfb8aa3b, v160
    v_fmamk_f32 v75, v75, 0xbfb8aa3b, v160
    v_fmamk_f32 v76, v76, 0xbfb8aa3b, v162
    v_fmamk_f32 v77, v77, 0xbfb8aa3b, v162
    v_fmamk_f32 v78, v78, 0xbfb8aa3b, v162
    v_fmamk_f32 v79, v79, 0xbfb8aa3b, v162
    s_setprio 1
    v_exp_f32 v64, v64
    v_mfma_f32_32x32x16_bf16 v[96:111], v[44:47], v[252:255], 0
    v_exp_f32 v65, v65
    s_cmp_gt_u32 s21, 3
    s_cselect_b32 s58, s18, 0
    buffer_load_dwordx4 v[144:147], v176, s[56:59], 0 offen sc1
    ds_write_b32 v148, v52 offset:54276
    ds_write_b32 v149, v53 offset:54276
    ds_write_b32 v150, v54 offset:54276
    ds_write_b32 v151, v55 offset:54276
    ds_read_b128 v[48:51], v179 offset:37392
    v_exp_f32 v66, v66
    v_exp_f32 v67, v67
    v_mfma_f32_32x32x16_bf16 v[96:111], v[28:31], v[200:203], v[96:111]
    v_exp_f32 v68, v68
    v_exp_f32 v69, v69
    v_exp_f32 v70, v70
    v_mfma_f32_32x32x16_bf16 v[96:111], v[32:35], v[204:207], v[96:111]
    v_exp_f32 v71, v71
    v_exp_f32 v72, v72
    v_exp_f32 v73, v73
    v_mfma_f32_32x32x16_bf16 v[96:111], v[36:39], v[208:211], v[96:111]
    v_exp_f32 v74, v74
    v_exp_f32 v75, v75
    v_exp_f32 v76, v76
    v_mfma_f32_32x32x16_bf16 v[96:111], v[40:43], v[212:215], v[96:111]
    v_exp_f32 v77, v77
    v_exp_f32 v78, v78
    v_exp_f32 v79, v79
    s_setprio 0
    v_add_u32 v148, v152, v183
    v_add_u32 v149, v153, v183
    v_add_u32 v150, v154, v183
    v_add_u32 v151, v155, v183
    v_add_f32 v64, 1.0, v64
    v_add_f32 v65, 1.0, v65
    v_add_f32 v66, 1.0, v66
    v_add_f32 v67, 1.0, v67
    v_add_f32 v68, 1.0, v68
    v_add_f32 v69, 1.0, v69
    v_add_f32 v70, 1.0, v70
    v_add_f32 v71, 1.0, v71
    v_add_f32 v72, 1.0, v72
    v_add_f32 v73, 1.0, v73
    v_add_f32 v74, 1.0, v74
    v_add_f32 v75, 1.0, v75
    v_add_f32 v76, 1.0, v76
    v_add_f32 v77, 1.0, v77
    v_add_f32 v78, 1.0, v78
    v_add_f32 v79, 1.0, v79
    s_setprio 1
    v_rcp_f32 v64, v64
    v_mfma_f32_32x32x16_bf16 v[112:127], v[28:31], v[232:235], 0
    v_rcp_f32 v65, v65
    s_waitcnt vmcnt(6)
    ds_read_b128 v[128:131], v172 offset:0
    ds_read_b128 v[132:135], v173 offset:0
    ds_read_b128 v[136:139], v174 offset:0
    ds_read_b128 v[140:143], v175 offset:0
    ds_read_b128 v[164:167], v177 offset:768
    ds_read_b128 v[152:155], v179 offset:33312
    ds_read_b32 v176, v178 offset:17216
    s_cmp_gt_u32 s21, 3
    s_cselect_b32 s38, s19, 0
    s_add_u32 m0, s20, 0
    v_rcp_f32 v66, v66
    v_rcp_f32 v67, v67
    v_mfma_f32_32x32x16_bf16 v[112:127], v[32:35], v[236:239], v[112:127]
    v_rcp_f32 v68, v68
    v_rcp_f32 v69, v69
    v_rcp_f32 v70, v70
    v_mfma_f32_32x32x16_bf16 v[112:127], v[36:39], v[240:243], v[112:127]
    v_rcp_f32 v71, v71
    v_rcp_f32 v72, v72
    v_rcp_f32 v73, v73
    v_mfma_f32_32x32x16_bf16 v[112:127], v[40:43], v[244:247], v[112:127]
    v_rcp_f32 v74, v74
    v_rcp_f32 v75, v75
    v_rcp_f32 v76, v76
    v_rcp_f32 v77, v77
    v_rcp_f32 v78, v78
    v_rcp_f32 v79, v79
    s_setprio 0
    s_waitcnt lgkmcnt(7)
    v_and_b32 v168, v171, v48
    v_fmac_f32 v168, v64, v80
    v_fmac_f32 v168, v65, v81
    v_fmac_f32 v168, v66, v82
    v_fmac_f32 v168, v67, v83
    v_and_b32 v169, v168, v49
    v_fmac_f32 v169, v68, v84
    v_fmac_f32 v169, v69, v85
    v_fmac_f32 v169, v70, v86
    v_fmac_f32 v169, v71, v87
    v_and_b32 v170, v169, v50
    v_fmac_f32 v170, v72, v88
    v_fmac_f32 v170, v73, v89
    v_fmac_f32 v170, v74, v90
    v_fmac_f32 v170, v75, v91
    v_and_b32 v171, v170, v51
    v_fmac_f32 v171, v76, v92
    v_fmac_f32 v171, v77, v93
    v_fmac_f32 v171, v78, v94
    v_fmac_f32 v171, v79, v95
    s_waitcnt lgkmcnt(2)
    v_or_b32 v164, v164, v180
    v_or_b32 v165, v165, v10
    v_or_b32 v166, v166, v11
    v_or_b32 v167, v167, v12
    v_fmamk_f32 v96, v96, 0xbfb8aa3b, v157
    v_fmamk_f32 v97, v97, 0xbfb8aa3b, v157
    v_fmamk_f32 v98, v98, 0xbfb8aa3b, v157
    v_fmamk_f32 v99, v99, 0xbfb8aa3b, v157
    v_fmamk_f32 v100, v100, 0xbfb8aa3b, v159
    v_fmamk_f32 v101, v101, 0xbfb8aa3b, v159
    v_fmamk_f32 v102, v102, 0xbfb8aa3b, v159
    v_fmamk_f32 v103, v103, 0xbfb8aa3b, v159
    v_fmamk_f32 v104, v104, 0xbfb8aa3b, v161
    v_fmamk_f32 v105, v105, 0xbfb8aa3b, v161
    v_fmamk_f32 v106, v106, 0xbfb8aa3b, v161
    v_fmamk_f32 v107, v107, 0xbfb8aa3b, v161
    v_fmamk_f32 v108, v108, 0xbfb8aa3b, v163
    v_fmamk_f32 v109, v109, 0xbfb8aa3b, v163
    v_fmamk_f32 v110, v110, 0xbfb8aa3b, v163
    v_fmamk_f32 v111, v111, 0xbfb8aa3b, v163
    s_setprio 1
    v_exp_f32 v96, v96
    v_mfma_f32_32x32x16_bf16 v[64:79], v[24:27], v[248:251], 0
    v_exp_f32 v97, v97
    buffer_load_dwordx4 v164, s[36:39], 0 offen  lds
    s_add_u32 m0, s20, 1024
    ds_write_b32 v148, v168 offset:54272
    buffer_load_dwordx4 v165, s[36:39], 0 offen  lds
    s_add_u32 m0, s20, 2048
    ds_write_b32 v149, v169 offset:54272
    buffer_load_dwordx4 v166, s[36:39], 0 offen  lds
    s_add_u32 m0, s20, 3072
    ds_write_b32 v150, v170 offset:54272
    buffer_load_dwordx4 v167, s[36:39], 0 offen  lds
    ds_write_b32 v151, v171 offset:54272
    v_exp_f32 v98, v98
    v_exp_f32 v99, v99
    v_mfma_f32_32x32x16_bf16 v[64:79], v[128:131], v[184:187], v[64:79]
    v_exp_f32 v100, v100
    v_exp_f32 v101, v101
    v_exp_f32 v102, v102
    v_mfma_f32_32x32x16_bf16 v[64:79], v[132:135], v[188:191], v[64:79]
    v_exp_f32 v103, v103
    v_exp_f32 v104, v104
    v_exp_f32 v105, v105
    v_mfma_f32_32x32x16_bf16 v[64:79], v[136:139], v[192:195], v[64:79]
    v_exp_f32 v106, v106
    v_exp_f32 v107, v107
    v_exp_f32 v108, v108
    v_mfma_f32_32x32x16_bf16 v[64:79], v[140:143], v[196:199], v[64:79]
    v_exp_f32 v109, v109
    v_exp_f32 v110, v110
    v_exp_f32 v111, v111
    s_setprio 0
    v_add_f32 v96, 1.0, v96
    v_add_f32 v97, 1.0, v97
    v_add_f32 v98, 1.0, v98
    v_add_f32 v99, 1.0, v99
    v_add_f32 v100, 1.0, v100
    v_add_f32 v101, 1.0, v101
    v_add_f32 v102, 1.0, v102
    v_add_f32 v103, 1.0, v103
    v_add_f32 v104, 1.0, v104
    v_add_f32 v105, 1.0, v105
    v_add_f32 v106, 1.0, v106
    v_add_f32 v107, 1.0, v107
    v_add_f32 v108, 1.0, v108
    v_add_f32 v109, 1.0, v109
    v_add_f32 v110, 1.0, v110
    v_add_f32 v111, 1.0, v111
    s_waitcnt lgkmcnt(4)
    v_add_u32 v60, v152, v181
    v_add_u32 v61, v153, v181
    v_add_u32 v62, v154, v181
    v_add_u32 v63, v155, v181
    v_add_u32 v176, v176, v182
    s_setprio 1
    v_rcp_f32 v96, v96
    v_mfma_f32_32x32x16_bf16 v[80:95], v[128:131], v[216:219], 0
    v_rcp_f32 v97, v97
    ds_read_b64 v[156:157], v60 offset:41472
    ds_read_b64 v[158:159], v61 offset:41472
    ds_read_b64 v[160:161], v62 offset:41472
    ds_read_b64 v[162:163], v63 offset:41472
    v_rcp_f32 v98, v98
    v_rcp_f32 v99, v99
    v_mfma_f32_32x32x16_bf16 v[80:95], v[132:135], v[220:223], v[80:95]
    v_rcp_f32 v100, v100
    v_rcp_f32 v101, v101
    v_rcp_f32 v102, v102
    v_mfma_f32_32x32x16_bf16 v[80:95], v[136:139], v[224:227], v[80:95]
    v_rcp_f32 v103, v103
    v_rcp_f32 v104, v104
    v_rcp_f32 v105, v105
    v_mfma_f32_32x32x16_bf16 v[80:95], v[140:143], v[228:231], v[80:95]
    v_rcp_f32 v106, v106
    v_rcp_f32 v107, v107
    v_rcp_f32 v108, v108
    v_rcp_f32 v109, v109
    v_rcp_f32 v110, v110
    v_rcp_f32 v111, v111
    s_setprio 0
    v_and_b32 v52, v55, v48
    v_fmac_f32 v52, v96, v112
    v_fmac_f32 v52, v97, v113
    v_fmac_f32 v52, v98, v114
    v_fmac_f32 v52, v99, v115
    v_and_b32 v53, v52, v49
    v_fmac_f32 v53, v100, v116
    v_fmac_f32 v53, v101, v117
    v_fmac_f32 v53, v102, v118
    v_fmac_f32 v53, v103, v119
    v_and_b32 v54, v53, v50
    v_fmac_f32 v54, v104, v120
    v_fmac_f32 v54, v105, v121
    v_fmac_f32 v54, v106, v122
    v_fmac_f32 v54, v107, v123
    v_and_b32 v55, v54, v51
    v_fmac_f32 v55, v108, v124
    v_fmac_f32 v55, v109, v125
    v_fmac_f32 v55, v110, v126
    v_fmac_f32 v55, v111, v127
    s_sub_u32 s21, s21, 1
    s_cmp_eq_u32 s21, 0
    s_cbranch_scc1 P2_FLUSH
    s_waitcnt lgkmcnt(0)
    v_fmamk_f32 v64, v64, 0xbfb8aa3b, v156
    v_fmamk_f32 v65, v65, 0xbfb8aa3b, v156
    v_fmamk_f32 v66, v66, 0xbfb8aa3b, v156
    v_fmamk_f32 v67, v67, 0xbfb8aa3b, v156
    v_fmamk_f32 v68, v68, 0xbfb8aa3b, v158
    v_fmamk_f32 v69, v69, 0xbfb8aa3b, v158
    v_fmamk_f32 v70, v70, 0xbfb8aa3b, v158
    v_fmamk_f32 v71, v71, 0xbfb8aa3b, v158
    v_fmamk_f32 v72, v72, 0xbfb8aa3b, v160
    v_fmamk_f32 v73, v73, 0xbfb8aa3b, v160
    v_fmamk_f32 v74, v74, 0xbfb8aa3b, v160
    v_fmamk_f32 v75, v75, 0xbfb8aa3b, v160
    v_fmamk_f32 v76, v76, 0xbfb8aa3b, v162
    v_fmamk_f32 v77, v77, 0xbfb8aa3b, v162
    v_fmamk_f32 v78, v78, 0xbfb8aa3b, v162
    v_fmamk_f32 v79, v79, 0xbfb8aa3b, v162
    s_setprio 1
    v_exp_f32 v64, v64
    v_mfma_f32_32x32x16_bf16 v[96:111], v[24:27], v[252:255], 0
    v_exp_f32 v65, v65
    s_cmp_gt_u32 s21, 3
    s_cselect_b32 s58, s18, 0
    buffer_load_dwordx4 v[44:47], v176, s[56:59], 0 offen sc1
    ds_write_b32 v148, v52 offset:54276
    ds_write_b32 v149, v53 offset:54276
    ds_write_b32 v150, v54 offset:54276
    ds_write_b32 v151, v55 offset:54276
    ds_read_b128 v[48:51], v179 offset:37408
    v_exp_f32 v66, v66
    v_exp_f32 v67, v67
    v_mfma_f32_32x32x16_bf16 v[96:111], v[128:131], v[200:203], v[96:111]
    v_exp_f32 v68, v68
    v_exp_f32 v69, v69
    v_exp_f32 v70, v70
    v_mfma_f32_32x32x16_bf16 v[96:111], v[132:135], v[204:207], v[96:111]
    v_exp_f32 v71, v71
    v_exp_f32 v72, v72
    v_exp_f32 v73, v73
    v_mfma_f32_32x32x16_bf16 v[96:111], v[136:139], v[208:211], v[96:111]
    v_exp_f32 v74, v74
    v_exp_f32 v75, v75
    v_exp_f32 v76, v76
    v_mfma_f32_32x32x16_bf16 v[96:111], v[140:143], v[212:215], v[96:111]
    v_exp_f32 v77, v77
    v_exp_f32 v78, v78
    v_exp_f32 v79, v79
    s_setprio 0
    v_add_u32 v148, v152, v183
    v_add_u32 v149, v153, v183
    v_add_u32 v150, v154, v183
    v_add_u32 v151, v155, v183
    v_add_f32 v64, 1.0, v64
    v_add_f32 v65, 1.0, v65
    v_add_f32 v66, 1.0, v66
    v_add_f32 v67, 1.0, v67
    v_add_f32 v68, 1.0, v68
    v_add_f32 v69, 1.0, v69
    v_add_f32 v70, 1.0, v70
    v_add_f32 v71, 1.0, v71
    v_add_f32 v72, 1.0, v72
    v_add_f32 v73, 1.0, v73
    v_add_f32 v74, 1.0, v74
    v_add_f32 v75, 1.0, v75
    v_add_f32 v76, 1.0, v76
    v_add_f32 v77, 1.0, v77
    v_add_f32 v78, 1.0, v78
    v_add_f32 v79, 1.0, v79
    s_setprio 1
    v_rcp_f32 v64, v64
    v_mfma_f32_32x32x16_bf16 v[112:127], v[128:131], v[232:235], 0
    v_rcp_f32 v65, v65
    s_waitcnt vmcnt(6)
    ds_read_b128 v[28:31], v172 offset:4096
    ds_read_b128 v[32:35], v173 offset:4096
    ds_read_b128 v[36:39], v174 offset:4096
    ds_read_b128 v[40:43], v175 offset:4096
    ds_read_b128 v[164:167], v177 offset:832
    ds_read_b128 v[152:155], v179 offset:33328
    ds_read_b32 v176, v178 offset:17280
    s_cmp_gt_u32 s21, 3
    s_cselect_b32 s38, s19, 0
    s_add_u32 m0, s20, 4096
    v_rcp_f32 v66, v66
    v_rcp_f32 v67, v67
    v_mfma_f32_32x32x16_bf16 v[112:127], v[132:135], v[236:239], v[112:127]
    v_rcp_f32 v68, v68
    v_rcp_f32 v69, v69
    v_rcp_f32 v70, v70
    v_mfma_f32_32x32x16_bf16 v[112:127], v[136:139], v[240:243], v[112:127]
    v_rcp_f32 v71, v71
    v_rcp_f32 v72, v72
    v_rcp_f32 v73, v73
    v_mfma_f32_32x32x16_bf16 v[112:127], v[140:143], v[244:247], v[112:127]
    v_rcp_f32 v74, v74
    v_rcp_f32 v75, v75
    v_rcp_f32 v76, v76
    v_rcp_f32 v77, v77
    v_rcp_f32 v78, v78
    v_rcp_f32 v79, v79
    s_setprio 0
    s_waitcnt lgkmcnt(7)
    v_and_b32 v168, v171, v48
    v_fmac_f32 v168, v64, v80
    v_fmac_f32 v168, v65, v81
    v_fmac_f32 v168, v66, v82
    v_fmac_f32 v168, v67, v83
    v_and_b32 v169, v168, v49
    v_fmac_f32 v169, v68, v84
    v_fmac_f32 v169, v69, v85
    v_fmac_f32 v169, v70, v86
    v_fmac_f32 v169, v71, v87
    v_and_b32 v170, v169, v50
    v_fmac_f32 v170, v72, v88
    v_fmac_f32 v170, v73, v89
    v_fmac_f32 v170, v74, v90
    v_fmac_f32 v170, v75, v91
    v_and_b32 v171, v170, v51
    v_fmac_f32 v171, v76, v92
    v_fmac_f32 v171, v77, v93
    v_fmac_f32 v171, v78, v94
    v_fmac_f32 v171, v79, v95
    s_waitcnt lgkmcnt(2)
    v_or_b32 v164, v164, v180
    v_or_b32 v165, v165, v10
    v_or_b32 v166, v166, v11
    v_or_b32 v167, v167, v12
    v_fmamk_f32 v96, v96, 0xbfb8aa3b, v157
    v_fmamk_f32 v97, v97, 0xbfb8aa3b, v157
    v_fmamk_f32 v98, v98, 0xbfb8aa3b, v157
    v_fmamk_f32 v99, v99, 0xbfb8aa3b, v157
    v_fmamk_f32 v100, v100, 0xbfb8aa3b, v159
    v_fmamk_f32 v101, v101, 0xbfb8aa3b, v159
    v_fmamk_f32 v102, v102, 0xbfb8aa3b, v159
    v_fmamk_f32 v103, v103, 0xbfb8aa3b, v159
    v_fmamk_f32 v104, v104, 0xbfb8aa3b, v161
    v_fmamk_f32 v105, v105, 0xbfb8aa3b, v161
    v_fmamk_f32 v106, v106, 0xbfb8aa3b, v161
    v_fmamk_f32 v107, v107, 0xbfb8aa3b, v161
    v_fmamk_f32 v108, v108, 0xbfb8aa3b, v163
    v_fmamk_f32 v109, v109, 0xbfb8aa3b, v163
    v_fmamk_f32 v110, v110, 0xbfb8aa3b, v163
    v_fmamk_f32 v111, v111, 0xbfb8aa3b, v163
    s_setprio 1
    v_exp_f32 v96, v96
    v_mfma_f32_32x32x16_bf16 v[64:79], v[56:59], v[248:251], 0
    v_exp_f32 v97, v97
    buffer_load_dwordx4 v164, s[36:39], 0 offen  lds
    s_add_u32 m0, s20, 5120
    ds_write_b32 v148, v168 offset:54272
    buffer_load_dwordx4 v165, s[36:39], 0 offen  lds
    s_add_u32 m0, s20, 6144
    ds_write_b32 v149, v169 offset:54272
    buffer_load_dwordx4 v166, s[36:39], 0 offen  lds
    s_add_u32 m0, s20, 7168
    ds_write_b32 v150, v170 offset:54272
    buffer_load_dwordx4 v167, s[36:39], 0 offen  lds
    ds_write_b32 v151, v171 offset:54272
    v_exp_f32 v98, v98
    v_exp_f32 v99, v99
    v_mfma_f32_32x32x16_bf16 v[64:79], v[28:31], v[184:187], v[64:79]
    v_exp_f32 v100, v100
    v_exp_f32 v101, v101
    v_exp_f32 v102, v102
    v_mfma_f32_32x32x16_bf16 v[64:79], v[32:35], v[188:191], v[64:79]
    v_exp_f32 v103, v103
    v_exp_f32 v104, v104
    v_exp_f32 v105, v105
    v_mfma_f32_32x32x16_bf16 v[64:79], v[36:39], v[192:195], v[64:79]
    v_exp_f32 v106, v106
    v_exp_f32 v107, v107
    v_exp_f32 v108, v108
    v_mfma_f32_32x32x16_bf16 v[64:79], v[40:43], v[196:199], v[64:79]
    v_exp_f32 v109, v109
    v_exp_f32 v110, v110
    v_exp_f32 v111, v111
    s_setprio 0
    v_add_f32 v96, 1.0, v96
    v_add_f32 v97, 1.0, v97
    v_add_f32 v98, 1.0, v98
    v_add_f32 v99, 1.0, v99
    v_add_f32 v100, 1.0, v100
    v_add_f32 v101, 1.0, v101
    v_add_f32 v102, 1.0, v102
    v_add_f32 v103, 1.0, v103
    v_add_f32 v104, 1.0, v104
    v_add_f32 v105, 1.0, v105
    v_add_f32 v106, 1.0, v106
    v_add_f32 v107, 1.0, v107
    v_add_f32 v108, 1.0, v108
    v_add_f32 v109, 1.0, v109
    v_add_f32 v110, 1.0, v110
    v_add_f32 v111, 1.0, v111
    s_waitcnt lgkmcnt(4)
    v_add_u32 v60, v152, v181
    v_add_u32 v61, v153, v181
    v_add_u32 v62, v154, v181
    v_add_u32 v63, v155, v181
    v_add_u32 v176, v176, v182
    s_setprio 1
    v_rcp_f32 v96, v96
    v_mfma_f32_32x32x16_bf16 v[80:95], v[28:31], v[216:219], 0
    v_rcp_f32 v97, v97
    ds_read_b64 v[156:157], v60 offset:41472
    ds_read_b64 v[158:159], v61 offset:41472
    ds_read_b64 v[160:161], v62 offset:41472
    ds_read_b64 v[162:163], v63 offset:41472
    v_rcp_f32 v98, v98
    v_rcp_f32 v99, v99
    v_mfma_f32_32x32x16_bf16 v[80:95], v[32:35], v[220:223], v[80:95]
    v_rcp_f32 v100, v100
    v_rcp_f32 v101, v101
    v_rcp_f32 v102, v102
    v_mfma_f32_32x32x16_bf16 v[80:95], v[36:39], v[224:227], v[80:95]
    v_rcp_f32 v103, v103
    v_rcp_f32 v104, v104
    v_rcp_f32 v105, v105
    v_mfma_f32_32x32x16_bf16 v[80:95], v[40:43], v[228:231], v[80:95]
    v_rcp_f32 v106, v106
    v_rcp_f32 v107, v107
    v_rcp_f32 v108, v108
    v_rcp_f32 v109, v109
    v_rcp_f32 v110, v110
    v_rcp_f32 v111, v111
    s_setprio 0
    v_and_b32 v52, v55, v48
    v_fmac_f32 v52, v96, v112
    v_fmac_f32 v52, v97, v113
    v_fmac_f32 v52, v98, v114
    v_fmac_f32 v52, v99, v115
    v_and_b32 v53, v52, v49
    v_fmac_f32 v53, v100, v116
    v_fmac_f32 v53, v101, v117
    v_fmac_f32 v53, v102, v118
    v_fmac_f32 v53, v103, v119
    v_and_b32 v54, v53, v50
    v_fmac_f32 v54, v104, v120
    v_fmac_f32 v54, v105, v121
    v_fmac_f32 v54, v106, v122
    v_fmac_f32 v54, v107, v123
    v_and_b32 v55, v54, v51
    v_fmac_f32 v55, v108, v124
    v_fmac_f32 v55, v109, v125
    v_fmac_f32 v55, v110, v126
    v_fmac_f32 v55, v111, v127
    s_sub_u32 s21, s21, 1
    s_cmp_eq_u32 s21, 0
    s_cbranch_scc1 P2_FLUSH
    s_waitcnt lgkmcnt(0)
    v_fmamk_f32 v64, v64, 0xbfb8aa3b, v156
    v_fmamk_f32 v65, v65, 0xbfb8aa3b, v156
    v_fmamk_f32 v66, v66, 0xbfb8aa3b, v156
    v_fmamk_f32 v67, v67, 0xbfb8aa3b, v156
    v_fmamk_f32 v68, v68, 0xbfb8aa3b, v158
    v_fmamk_f32 v69, v69, 0xbfb8aa3b, v158
    v_fmamk_f32 v70, v70, 0xbfb8aa3b, v158
    v_fmamk_f32 v71, v71, 0xbfb8aa3b, v158
    v_fmamk_f32 v72, v72, 0xbfb8aa3b, v160
    v_fmamk_f32 v73, v73, 0xbfb8aa3b, v160
    v_fmamk_f32 v74, v74, 0xbfb8aa3b, v160
    v_fmamk_f32 v75, v75, 0xbfb8aa3b, v160
    v_fmamk_f32 v76, v76, 0xbfb8aa3b, v162
    v_fmamk_f32 v77, v77, 0xbfb8aa3b, v162
    v_fmamk_f32 v78, v78, 0xbfb8aa3b, v162
    v_fmamk_f32 v79, v79, 0xbfb8aa3b, v162
    s_setprio 1
    v_exp_f32 v64, v64
    v_mfma_f32_32x32x16_bf16 v[96:111], v[56:59], v[252:255], 0
    v_exp_f32 v65, v65
    s_cmp_gt_u32 s21, 3
    s_cselect_b32 s58, s18, 0
    buffer_load_dwordx4 v[24:27], v176, s[56:59], 0 offen sc1
    ds_write_b32 v148, v52 offset:54276
    ds_write_b32 v149, v53 offset:54276
    ds_write_b32 v150, v54 offset:54276
    ds_write_b32 v151, v55 offset:54276
    ds_read_b128 v[48:51], v179 offset:37424
    v_exp_f32 v66, v66
    v_exp_f32 v67, v67
    v_mfma_f32_32x32x16_bf16 v[96:111], v[28:31], v[200:203], v[96:111]
    v_exp_f32 v68, v68
    v_exp_f32 v69, v69
    v_exp_f32 v70, v70
    v_mfma_f32_32x32x16_bf16 v[96:111], v[32:35], v[204:207], v[96:111]
    v_exp_f32 v71, v71
    v_exp_f32 v72, v72
    v_exp_f32 v73, v73
    v_mfma_f32_32x32x16_bf16 v[96:111], v[36:39], v[208:211], v[96:111]
    v_exp_f32 v74, v74
    v_exp_f32 v75, v75
    v_exp_f32 v76, v76
    v_mfma_f32_32x32x16_bf16 v[96:111], v[40:43], v[212:215], v[96:111]
    v_exp_f32 v77, v77
    v_exp_f32 v78, v78
    v_exp_f32 v79, v79
    s_setprio 0
    v_add_u32 v148, v152, v183
    v_add_u32 v149, v153, v183
    v_add_u32 v150, v154, v183
    v_add_u32 v151, v155, v183
    v_add_f32 v64, 1.0, v64
    v_add_f32 v65, 1.0, v65
    v_add_f32 v66, 1.0, v66
    v_add_f32 v67, 1.0, v67
    v_add_f32 v68, 1.0, v68
    v_add_f32 v69, 1.0, v69
    v_add_f32 v70, 1.0, v70
    v_add_f32 v71, 1.0, v71
    v_add_f32 v72, 1.0, v72
    v_add_f32 v73, 1.0, v73
    v_add_f32 v74, 1.0, v74
    v_add_f32 v75, 1.0, v75
    v_add_f32 v76, 1.0, v76
    v_add_f32 v77, 1.0, v77
    v_add_f32 v78, 1.0, v78
    v_add_f32 v79, 1.0, v79
    s_setprio 1
    v_rcp_f32 v64, v64
    v_mfma_f32_32x32x16_bf16 v[112:127], v[28:31], v[232:235], 0
    v_rcp_f32 v65, v65
    s_waitcnt vmcnt(6)
    ds_read_b128 v[128:131], v172 offset:0
    ds_read_b128 v[132:135], v173 offset:0
    ds_read_b128 v[136:139], v174 offset:0
    ds_read_b128 v[140:143], v175 offset:0
    ds_read_b128 v[164:167], v177 offset:896
    ds_read_b128 v[152:155], v179 offset:33344
    ds_read_b32 v176, v178 offset:17344
    s_cmp_gt_u32 s21, 3
    s_cselect_b32 s38, s19, 0
    s_add_u32 m0, s20, 0
    v_rcp_f32 v66, v66
    v_rcp_f32 v67, v67
    v_mfma_f32_32x32x16_bf16 v[112:127], v[32:35], v[236:239], v[112:127]
    v_rcp_f32 v68, v68
    v_rcp_f32 v69, v69
    v_rcp_f32 v70, v70
    v_mfma_f32_32x32x16_bf16 v[112:127], v[36:39], v[240:243], v[112:127]
    v_rcp_f32 v71, v71
    v_rcp_f32 v72, v72
    v_rcp_f32 v73, v73
    v_mfma_f32_32x32x16_bf16 v[112:127], v[40:43], v[244:247], v[112:127]
    v_rcp_f32 v74, v74
    v_rcp_f32 v75, v75
    v_rcp_f32 v76, v76
    v_rcp_f32 v77, v77
    v_rcp_f32 v78, v78
    v_rcp_f32 v79, v79
    s_setprio 0
    s_waitcnt lgkmcnt(7)
    v_and_b32 v168, v171, v48
    v_fmac_f32 v168, v64, v80
    v_fmac_f32 v168, v65, v81
    v_fmac_f32 v168, v66, v82
    v_fmac_f32 v168, v67, v83
    v_and_b32 v169, v168, v49
    v_fmac_f32 v169, v68, v84
    v_fmac_f32 v169, v69, v85
    v_fmac_f32 v169, v70, v86
    v_fmac_f32 v169, v71, v87
    v_and_b32 v170, v169, v50
    v_fmac_f32 v170, v72, v88
    v_fmac_f32 v170, v73, v89
    v_fmac_f32 v170, v74, v90
    v_fmac_f32 v170, v75, v91
    v_and_b32 v171, v170, v51
    v_fmac_f32 v171, v76, v92
    v_fmac_f32 v171, v77, v93
    v_fmac_f32 v171, v78, v94
    v_fmac_f32 v171, v79, v95
    s_waitcnt lgkmcnt(2)
    v_or_b32 v164, v164, v180
    v_or_b32 v165, v165, v10
    v_or_b32 v166, v166, v11
    v_or_b32 v167, v167, v12
    v_fmamk_f32 v96, v96, 0xbfb8aa3b, v157
    v_fmamk_f32 v97, v97, 0xbfb8aa3b, v157
    v_fmamk_f32 v98, v98, 0xbfb8aa3b, v157
    v_fmamk_f32 v99, v99, 0xbfb8aa3b, v157
    v_fmamk_f32 v100, v100, 0xbfb8aa3b, v159
    v_fmamk_f32 v101, v101, 0xbfb8aa3b, v159
    v_fmamk_f32 v102, v102, 0xbfb8aa3b, v159
    v_fmamk_f32 v103, v103, 0xbfb8aa3b, v159
    v_fmamk_f32 v104, v104, 0xbfb8aa3b, v161
    v_fmamk_f32 v105, v105, 0xbfb8aa3b, v161
    v_fmamk_f32 v106, v106, 0xbfb8aa3b, v161
    v_fmamk_f32 v107, v107, 0xbfb8aa3b, v161
    v_fmamk_f32 v108, v108, 0xbfb8aa3b, v163
    v_fmamk_f32 v109, v109, 0xbfb8aa3b, v163
    v_fmamk_f32 v110, v110, 0xbfb8aa3b, v163
    v_fmamk_f32 v111, v111, 0xbfb8aa3b, v163
    s_setprio 1
    v_exp_f32 v96, v96
    v_mfma_f32_32x32x16_bf16 v[64:79], v[144:147], v[248:251], 0
    v_exp_f32 v97, v97
    buffer_load_dwordx4 v164, s[36:39], 0 offen  lds
    s_add_u32 m0, s20, 1024
    ds_write_b32 v148, v168 offset:54272
    buffer_load_dwordx4 v165, s[36:39], 0 offen  lds
    s_add_u32 m0, s20, 2048
    ds_write_b32 v149, v169 offset:54272
    buffer_load_dwordx4 v166, s[36:39], 0 offen  lds
    s_add_u32 m0, s20, 3072
    ds_write_b32 v150, v170 offset:54272
    buffer_load_dwordx4 v167, s[36:39], 0 offen  lds
    ds_write_b32 v151, v171 offset:54272
    v_exp_f32 v98, v98
    v_exp_f32 v99, v99
    v_mfma_f32_32x32x16_bf16 v[64:79], v[128:131], v[184:187], v[64:79]
    v_exp_f32 v100, v100
    v_exp_f32 v101, v101
    v_exp_f32 v102, v102
    v_mfma_f32_32x32x16_bf16 v[64:79], v[132:135], v[188:191], v[64:79]
    v_exp_f32 v103, v103
    v_exp_f32 v104, v104
    v_exp_f32 v105, v105
    v_mfma_f32_32x32x16_bf16 v[64:79], v[136:139], v[192:195], v[64:79]
    v_exp_f32 v106, v106
    v_exp_f32 v107, v107
    v_exp_f32 v108, v108
    v_mfma_f32_32x32x16_bf16 v[64:79], v[140:143], v[196:199], v[64:79]
    v_exp_f32 v109, v109
    v_exp_f32 v110, v110
    v_exp_f32 v111, v111
    s_setprio 0
    v_add_f32 v96, 1.0, v96
    v_add_f32 v97, 1.0, v97
    v_add_f32 v98, 1.0, v98
    v_add_f32 v99, 1.0, v99
    v_add_f32 v100, 1.0, v100
    v_add_f32 v101, 1.0, v101
    v_add_f32 v102, 1.0, v102
    v_add_f32 v103, 1.0, v103
    v_add_f32 v104, 1.0, v104
    v_add_f32 v105, 1.0, v105
    v_add_f32 v106, 1.0, v106
    v_add_f32 v107, 1.0, v107
    v_add_f32 v108, 1.0, v108
    v_add_f32 v109, 1.0, v109
    v_add_f32 v110, 1.0, v110
    v_add_f32 v111, 1.0, v111
    s_waitcnt lgkmcnt(4)
    v_add_u32 v60, v152, v181
    v_add_u32 v61, v153, v181
    v_add_u32 v62, v154, v181
    v_add_u32 v63, v155, v181
    v_add_u32 v176, v176, v182
    s_setprio 1
    v_rcp_f32 v96, v96
    v_mfma_f32_32x32x16_bf16 v[80:95], v[128:131], v[216:219], 0
    v_rcp_f32 v97, v97
    ds_read_b64 v[156:157], v60 offset:41472
    ds_read_b64 v[158:159], v61 offset:41472
    ds_read_b64 v[160:161], v62 offset:41472
    ds_read_b64 v[162:163], v63 offset:41472
    v_rcp_f32 v98, v98
    v_rcp_f32 v99, v99
    v_mfma_f32_32x32x16_bf16 v[80:95], v[132:135], v[220:223], v[80:95]
    v_rcp_f32 v100, v100
    v_rcp_f32 v101, v101
    v_rcp_f32 v102, v102
    v_mfma_f32_32x32x16_bf16 v[80:95], v[136:139], v[224:227], v[80:95]
    v_rcp_f32 v103, v103
    v_rcp_f32 v104, v104
    v_rcp_f32 v105, v105
    v_mfma_f32_32x32x16_bf16 v[80:95], v[140:143], v[228:231], v[80:95]
    v_rcp_f32 v106, v106
    v_rcp_f32 v107, v107
    v_rcp_f32 v108, v108
    v_rcp_f32 v109, v109
    v_rcp_f32 v110, v110
    v_rcp_f32 v111, v111
    s_setprio 0
    v_and_b32 v52, v55, v48
    v_fmac_f32 v52, v96, v112
    v_fmac_f32 v52, v97, v113
    v_fmac_f32 v52, v98, v114
    v_fmac_f32 v52, v99, v115
    v_and_b32 v53, v52, v49
    v_fmac_f32 v53, v100, v116
    v_fmac_f32 v53, v101, v117
    v_fmac_f32 v53, v102, v118
    v_fmac_f32 v53, v103, v119
    v_and_b32 v54, v53, v50
    v_fmac_f32 v54, v104, v120
    v_fmac_f32 v54, v105, v121
    v_fmac_f32 v54, v106, v122
    v_fmac_f32 v54, v107, v123
    v_and_b32 v55, v54, v51
    v_fmac_f32 v55, v108, v124
    v_fmac_f32 v55, v109, v125
    v_fmac_f32 v55, v110, v126
    v_fmac_f32 v55, v111, v127
    v_add_u32 v177, 256, v177
    v_add_u32 v178, 256, v178
    v_add_u32 v179, 64, v179
    s_sub_u32 s21, s21, 1
    s_cmp_lg_u32 s21, 0
    s_cbranch_scc1 P2_LOOPS
    s_branch P2_FLUSH
P2_FLUSH:
    ds_write_b32 v148, v52 offset:54276
    ds_write_b32 v149, v53 offset:54276
    ds_write_b32 v150, v54 offset:54276
    ds_write_b32 v151, v55 offset:54276
P2_MAIN_DONE:
    s_waitcnt vmcnt(0) lgkmcnt(0)
    s_barrier
    v_and_b32 v24, 0xff, v7
    v_and_b32 v25, 0xff00, v7
    v_add_u32 v25, v25, v3
    v_add_u32 v25, 54272, v25
P2_FOLD0:
    v_cmpx_lt_u32 vcc, 0, v24
    s_cbranch_execz P2_FOLD_DONE0
    ds_read_b128 v[32:35], v25
    v_add_u32 v24, -1, v24
    v_add_u32 v25, 0x100, v25
    s_waitcnt lgkmcnt(0)
    v_add_f32 v16, v16, v32
    v_add_f32 v17, v17, v33
    v_add_f32 v18, v18, v34
    v_add_f32 v19, v19, v35
    s_branch P2_FOLD0
P2_FOLD_DONE0:
    s_mov_b64 exec, -1
    v_and_b32 v24, 0xff, v8
    v_and_b32 v25, 0xff00, v8
    v_add_u32 v25, v25, v3
    v_add_u32 v25, 62464, v25
P2_FOLD1:
    v_cmpx_lt_u32 vcc, 0, v24
    s_cbranch_execz P2_FOLD_DONE1
    ds_read_b128 v[32:35], v25
    v_add_u32 v24, -1, v24
    v_add_u32 v25, 0x100, v25
    s_waitcnt lgkmcnt(0)
    v_add_f32 v20, v20, v32
    v_add_f32 v21, v21, v33
    v_add_f32 v22, v22, v34
    v_add_f32 v23, v23, v35
    s_branch P2_FOLD1
P2_FOLD_DONE1:
    s_mov_b64 exec, -1
    s_cmp_lt_u32 s23, s24
    s_cbranch_scc1 P2_ROUND
    v_lshrrev_b32 v5, 4, v0
    v_and_b32 v6, 15, v0
    v_lshlrev_b32 v5, 7, v5
    v_lshl_add_u32 v5, v6, 2, v5
    v_add_u32 v6, 0x1000, v5
    v_add_u32 v24, 138240, v3
    ds_read_b128 v[32:35], v24
    v_cvt_pk_bf16_f32 v36, v16, v18
    v_cvt_pk_bf16_f32 v37, v17, v19
    v_lshlrev_b32 v28, 16, v36
    v_and_b32 v30, 0xffff0000, v36
    v_lshlrev_b32 v29, 16, v37
    v_and_b32 v31, 0xffff0000, v37
    s_waitcnt lgkmcnt(0)
    v_add_f32 v28, v28, v32
    v_add_f32 v29, v29, v33
    v_add_f32 v30, v30, v34
    v_add_f32 v31, v31, v35
    v_cvt_pk_bf16_f32 v36, v28, v30
    v_cvt_pk_bf16_f32 v37, v29, v31
    v_lshlrev_b32 v28, 16, v36
    v_and_b32 v30, 0xffff0000, v36
    v_lshlrev_b32 v29, 16, v37
    v_and_b32 v31, 0xffff0000, v37
    v_mul_f32 v32, 0xbfb8aa3b, v28
    v_mul_f32 v33, 0xbfb8aa3b, v29
    v_mul_f32 v34, 0xbfb8aa3b, v30
    v_mul_f32 v35, 0xbfb8aa3b, v31
    v_exp_f32 v32, v32
    v_exp_f32 v33, v33
    v_exp_f32 v34, v34
    v_exp_f32 v35, v35
    v_add_f32 v32, 1.0, v32
    v_add_f32 v33, 1.0, v33
    v_add_f32 v34, 1.0, v34
    v_add_f32 v35, 1.0, v35
    v_rcp_f32 v32, v32
    v_rcp_f32 v33, v33
    v_rcp_f32 v34, v34
    v_rcp_f32 v35, v35
    v_mul_f32 v28, v28, v32
    v_mul_f32 v29, v29, v33
    v_mul_f32 v30, v30, v34
    v_mul_f32 v31, v31, v35
    v_cvt_pk_bf16_f32 v38, v28, v30
    v_cvt_pk_bf16_f32 v39, v29, v31
    buffer_store_dword v38, v5, s[44:47], 0 offen
    buffer_store_dword v39, v5, s[44:47], 0 offen offset:64
    v_add_u32 v24, 146432, v3
    ds_read_b128 v[32:35], v24
    v_cvt_pk_bf16_f32 v36, v20, v22
    v_cvt_pk_bf16_f32 v37, v21, v23
    v_lshlrev_b32 v28, 16, v36
    v_and_b32 v30, 0xffff0000, v36
    v_lshlrev_b32 v29, 16, v37
    v_and_b32 v31, 0xffff0000, v37
    s_waitcnt lgkmcnt(0)
    v_add_f32 v28, v28, v32
    v_add_f32 v29, v29, v33
    v_add_f32 v30, v30, v34
    v_add_f32 v31, v31, v35
    v_cvt_pk_bf16_f32 v36, v28, v30
    v_cvt_pk_bf16_f32 v37, v29, v31
    v_lshlrev_b32 v28, 16, v36
    v_and_b32 v30, 0xffff0000, v36
    v_lshlrev_b32 v29, 16, v37
    v_and_b32 v31, 0xffff0000, v37
    v_mul_f32 v32, 0xbfb8aa3b, v28
    v_mul_f32 v33, 0xbfb8aa3b, v29
    v_mul_f32 v34, 0xbfb8aa3b, v30
    v_mul_f32 v35, 0xbfb8aa3b, v31
    v_exp_f32 v32, v32
    v_exp_f32 v33, v33
    v_exp_f32 v34, v34
    v_exp_f32 v35, v35
    v_add_f32 v32, 1.0, v32
    v_add_f32 v33, 1.0, v33
    v_add_f32 v34, 1.0, v34
    v_add_f32 v35, 1.0, v35
    v_rcp_f32 v32, v32
    v_rcp_f32 v33, v33
    v_rcp_f32 v34, v34
    v_rcp_f32 v35, v35
    v_mul_f32 v28, v28, v32
    v_mul_f32 v29, v29, v33
    v_mul_f32 v30, v30, v34
    v_mul_f32 v31, v31, v35
    v_cvt_pk_bf16_f32 v40, v28, v30
    v_cvt_pk_bf16_f32 v41, v29, v31
    buffer_store_dword v40, v6, s[44:47], 0 offen
    buffer_store_dword v41, v6, s[44:47], 0 offen offset:64
P2_END:
    s_endpgm
.section .rodata,"a"
.p2align 6
.amdhsa_kernel p1_kernel
  .amdhsa_next_free_vgpr 96
  .amdhsa_next_free_sgpr 100
  .amdhsa_accum_offset 96
  .amdhsa_group_segment_fixed_size 0
  .amdhsa_kernarg_size 80
  .amdhsa_user_sgpr_count 2
  .amdhsa_user_sgpr_kernarg_segment_ptr 1
  .amdhsa_system_sgpr_workgroup_id_x 1
.end_amdhsa_kernel
.p2align 6
.amdhsa_kernel p2_kernel
  .amdhsa_next_free_vgpr 256
  .amdhsa_next_free_sgpr 100
  .amdhsa_accum_offset 256
  .amdhsa_group_segment_fixed_size 0
  .amdhsa_kernarg_size 80
  .amdhsa_user_sgpr_count 2
  .amdhsa_user_sgpr_kernarg_segment_ptr 1
  .amdhsa_system_sgpr_workgroup_id_x 1
.end_amdhsa_kernel
```
